```python
import torch

def _softmax(x, axis=-1):
    return torch.softmax(x, dim=axis)
def _gelu(x):
    return torch.nn.functional.gelu(x, approximate="tanh")
def _silu(x):
    return torch.nn.functional.silu(x)
def _sigmoid(x):
    return torch.sigmoid(x)
def _layernorm(x, axis=-1, eps=1e-5):
    m = x.mean(dim=axis, keepdim=True)
    v = x.var(dim=axis, keepdim=True, unbiased=False)
    return (x - m) / torch.sqrt(v + eps)
def _scatter_add(tgt, idx, src, axis=0):
    return tgt.clone().index_add_(axis, idx, src)
def _segment_sum(src, seg, n):
    out = torch.zeros((n,) + src.shape[1:], dtype=src.dtype)
    return out.index_add_(0, seg, src)
def _pad(x, pw):
    flat = tuple(v for pair in reversed(pw) for v in pair)
    return torch.nn.functional.pad(x, flat)

kernel_name = 'standalone__batchnorm__sampling'

def setup_inputs():

    _w = (lambda a: (lambda t: t.to(torch.bfloat16) if t.is_floating_point() else t)(torch.as_tensor(a)))
    B, S, C = 1024, 8, 576
    K = 3
    return {
        "x": _w((lambda *s: torch.randn(*s, dtype=torch.bfloat16) * 0.05)(B, S, C)),
        "w": _w((lambda *s: torch.randn(*s, dtype=torch.bfloat16) * 0.05)(K, C, C) * (1.0 / (K * C) ** 0.5)),
        "mean": _w((lambda *s: torch.randn(*s, dtype=torch.bfloat16) * 0.05)(C) * 0.1),
        "var": _w(torch.abs((lambda *s: torch.randn(*s, dtype=torch.bfloat16) * 0.05)(C)) + 0.5),
        "g": _w((lambda *s: torch.randn(*s, dtype=torch.bfloat16) * 0.05)(C) + 1.0),
        "b": _w((lambda *s: torch.randn(*s, dtype=torch.bfloat16) * 0.05)(C) * 0.1),
    }

def reference(x, w, mean, var, g, b):
    K = 3
    P = K // 2
    S = x.shape[1]
    xp = _pad(x, ((0, 0), (P, P), (0, 0)))
    y = sum(torch.einsum('bsc,cd->bsd', xp[:, k:k + S, :], w[k]) for k in range(K))
    inv_std = 1.0 / torch.sqrt(var + 1e-5)
    y = (y - mean) * (g * inv_std) + b
    return _silu(y)
```

```asm
; @launch grid=(256,1,1) block=(512,1,1) lds=163840
.amdgcn_target "amdgcn-amd-amdhsa--gfx950"
.text
.globl standalone__batchnorm__sampling_kernel
.p2align 12
L_base:
.fill 832, 4, 0xbf810000
.p2align 8
.type standalone__batchnorm__sampling_kernel,@function
standalone__batchnorm__sampling_kernel:
    s_cmpk_ge_u32 s2, 0x100
    s_cbranch_scc1 L_end
    s_load_dwordx2 s[20:21], s[0:1], 0
    s_load_dwordx2 s[24:25], s[0:1], 8
    v_lshrrev_b32 v1, 6, v0
    v_and_b32 v0, 63, v0
    s_mul_i32 s3, s2, 0x101
    v_readfirstlane_b32 s36, v1
    s_addk_i32 s3, 0x700
    s_bfe_u32 s37, s3, 0x80003
    s_xor_b32 s37, s37, 31
    s_mul_hi_u32 s38, s37, 0x1c71c71d
    s_mul_i32 s32, s38, 9
    s_sub_u32 s39, s37, s32
    s_lshr_b32 s40, s38, 2
    s_and_b32 s41, s38, 3
    s_cmp_lt_u32 s36, 4
    s_cbranch_scc1 L_cons
    s_mov_b32 s22, 9437184
    s_mov_b32 s23, 0x20000
    s_mov_b32 s26, 1990656
    s_mov_b32 s27, 0x20000
    s_and_b32 s42, s36, 3
    s_and_b32 s43, s36, 1
    s_lshl_b32 s43, s43, 2
    v_lshrrev_b32 v16, 3, v0
    v_and_b32 v17, 7, v0
    v_bfe_u32 v8, v0, 4, 1
    v_lshl_or_b32 v8, v8, 1, s43
    v_xor_b32 v8, v8, v17
    v_mul_u32_u24 v9, 1152, v16
    v_lshl_add_u32 v5, v8, 4, v9
    v_lshrrev_b32 v8, 4, v0
    v_or_b32 v8, s43, v8
    v_xor_b32 v8, v8, v17
    v_lshlrev_b32 v9, 3, v9
    v_lshl_add_u32 v2, v8, 4, v9
    s_mul_i32 s81, s42, 3072
    s_mul_i32 s33, s42, 9216
    s_brev_b32 s34, s42
    s_cmpk_ge_u32 s37, 252
    s_cbranch_scc1 L_first_s
    s_lshl_b32 s32, s39, 7
    s_add_u32 s55, s33, s32
    s_add_u32 s56, s55, 662528
    s_add_u32 s57, s55, 1325056
    s_lshr_b32 s80, s34, 17
    s_mul_i32 s3, s40, 18
    s_lshl2_add_u32 s3, s41, s3
    s_add_u32 s3, s3, s42
    s_mul_i32 s45, s3, 73728
    s_add_u32 s46, s45, 128
    s_add_u32 s47, s45, 256
    s_add_u32 s48, s45, 384
    s_lshl2_add_u32 s33, s37, s42
    s_mul_i32 s58, s33, 9216
    s_min_u32 s33, s33, 863
    s_mul_hi_u32 s3, s33, 14913081
    s_mul_i32 s3, s3, 589824
    s_lshl_b32 s33, s33, 8
    s_add_u32 s59, s3, s33
    v_mul_u32_u24 v30, 1152, v17
    v_lshl_add_u32 v30, v16, 7, v30
    v_mul_u32_u24 v31, 73728, v16
    v_lshl_add_u32 v31, v17, 7, v31
    s_add_u32 m0, s81, 0
    s_nop 0
    s_waitcnt lgkmcnt(0)
    buffer_load_dwordx4 v5, s[24:27], s55 offen lds
    buffer_load_dwordx4 v5, s[24:27], s56 offen offset:1024 lds
    buffer_load_dwordx4 v5, s[24:27], s57 offen offset:2048 lds
    s_mov_b64 exec, 0x303
    buffer_load_dword v33, v31, s[24:27], s59 offen
    s_bfm_b64 exec, 16, 0
    buffer_load_dword v32, v30, s[20:23], s58 offen
    s_mov_b64 exec, -1
    s_add_u32 m0, s80, 49152
    v_add_u32 v5, 36864, v5
    buffer_load_dwordx4 v2, s[20:23], s45 offen lds
    buffer_load_dwordx4 v2, s[20:23], s46 offen offset:1024 lds
    buffer_load_dwordx4 v2, s[20:23], s47 offen offset:2048 lds
    buffer_load_dwordx4 v2, s[20:23], s48 offen offset:3072 lds
    s_branch L_cont_n
L_first_s:
    s_lshl_b32 s32, s39, 8
    s_add_u32 s49, s33, s32
    s_add_u32 s50, s49, 662528
    s_add_u32 s51, s49, 1325056
    s_add_u32 s52, s49, 128
    s_add_u32 s53, s49, 662656
    s_add_u32 s54, s49, 1325184
    s_lshr_b32 s80, s34, 18
    s_mul_i32 s3, s43, 18432
    s_lshr_b32 s32, s42, 1
    s_mul_i32 s32, s32, 4608
    s_add_u32 s3, s3, s32
    s_add_u32 s45, s3, 9289728
    s_add_u32 s46, s3, 9289856
    s_add_u32 s47, s3, 9292032
    s_add_u32 s48, s3, 9292160
    s_add_u32 m0, s80, 110592
    s_nop 0
    s_waitcnt lgkmcnt(0)
    buffer_load_dwordx4 v2, s[20:23], s45 offen lds
    buffer_load_dwordx4 v2, s[20:23], s46 offen offset:1024 lds
    s_add_u32 m0, s80, 112640
    s_nop 0
    buffer_load_dwordx4 v2, s[20:23], s47 offen lds
    buffer_load_dwordx4 v2, s[20:23], s48 offen offset:1024 lds
    s_add_u32 m0, s81, 0
    v_add_u32 v2, 0x80, v2
    buffer_load_dwordx4 v5, s[24:27], s49 offen lds
    buffer_load_dwordx4 v5, s[24:27], s50 offen offset:1024 lds
    buffer_load_dwordx4 v5, s[24:27], s51 offen offset:2048 lds
    s_add_u32 m0, s81, 12288
    s_nop 0
    buffer_load_dwordx4 v5, s[24:27], s52 offen lds
    buffer_load_dwordx4 v5, s[24:27], s53 offen offset:1024 lds
    buffer_load_dwordx4 v5, s[24:27], s54 offen offset:2048 lds
    s_branch L_load_s
L_cont_n:
    s_load_dwordx8 s[8:15], s[0:1], 16
    s_add_u32 s49, s45, 4608
    s_add_u32 s50, s45, 4736
    s_add_u32 s51, s45, 4864
    s_add_u32 s52, s45, 4992
    s_mul_i32 s3, s40, 36
    s_add_u32 s3, s3, s41
    s_lshl2_add_u32 s3, s3, s42
    s_mul_i32 s3, s3, 9216
    s_add_u32 s53, s3, 1179648
    v_add_u32 v9, 1, v16
    v_bfe_u32 v9, v9, 1, 1
    s_lshl_b32 s3, s42, 1
    v_or_b32 v9, s3, v9
    v_xor_b32 v9, v9, v17
    v_mul_u32_u24 v8, 1152, v16
    v_lshl_add_u32 v3, v9, 4, v8
    s_mul_i32 s82, s42, 1152
    s_add_u32 s82, s82, 32896
    s_lshl_b32 s33, s37, 2
    s_add_u32 s33, s33, s42
    s_mul_i32 s32, s33, 9216
    v_and_b32 v13, 15, v0
    v_mul_u32_u24 v15, 1152, v13
    v_add_u32 v14, s32, v15
    s_sub_u32 s3, s33, 896
    s_mul_i32 s32, s3, 2304
    s_add_u32 s32, s32, 9280512
    s_cmp_lt_u32 s3, 64
    s_cselect_b32 s32, s32, 1073741824
    v_add_u32 v15, s32, v15
    v_cmp_lt_u32 vcc, 7, v13
    s_lshl_b32 s3, s33, 1
    v_and_or_b32 v18, v0, 1, s3
    v_cndmask_b32 v14, v14, v15, vcc
    v_mov_b32 v15, 1073741824
    v_cmp_lt_u32 vcc, 9, v13
    v_lshrrev_b32 v13, 4, v0
    v_lshlrev_b32 v13, 7, v13
    v_cndmask_b32 v14, v14, v15, vcc
    v_add_u32 v10, v13, v14
    v_mul_u32_u24 v14, 3641, v18
    v_lshrrev_b32 v14, 21, v14
    v_mul_u32_u24 v14, 589824, v14
    v_lshl_add_u32 v14, v18, 7, v14
    v_lshrrev_b32 v13, 1, v0
    v_mul_u32_u24 v13, 73728, v13
    s_cmp_lt_u32 s3, 1728
    s_cselect_b32 s3, 0, 1073741824
    v_add3_u32 v11, v13, v14, s3
    v_add_u32 v10, 256, v10
    v_add_u32 v11, 147456, v11
    s_add_u32 m0, s81, 12288
    s_nop 0
    buffer_load_dwordx4 v5, s[24:27], s55 offen lds
    buffer_load_dwordx4 v5, s[24:27], s56 offen offset:1024 lds
    buffer_load_dwordx4 v5, s[24:27], s57 offen offset:2048 lds
    s_waitcnt vmcnt(9)
    s_barrier
    s_add_u32 m0, s80, 53248
    v_add_u32 v5, 36864, v5
    buffer_load_dwordx4 v2, s[20:23], s49 offen lds
    buffer_load_dwordx4 v2, s[20:23], s50 offen offset:1024 lds
    buffer_load_dwordx4 v2, s[20:23], s51 offen offset:2048 lds
    buffer_load_dwordx4 v2, s[20:23], s52 offen offset:3072 lds
    s_add_u32 m0, s82, 49152
    s_nop 0
    buffer_load_dwordx4 v3, s[20:23], s53 offen lds
    s_add_u32 m0, s81, 24576
    v_add_u32 v2, 0x80, v2
    buffer_load_dwordx4 v5, s[24:27], s55 offen lds
    buffer_load_dwordx4 v5, s[24:27], s56 offen offset:1024 lds
    buffer_load_dwordx4 v5, s[24:27], s57 offen offset:2048 lds
    s_waitcnt vmcnt(11)
    s_barrier
    s_add_u32 m0, s80, 86656
    v_add_u32 v3, 0x80, v3
    buffer_load_dwordx4 v2, s[20:23], s45 offen lds
    buffer_load_dwordx4 v2, s[20:23], s46 offen offset:1024 lds
    buffer_load_dwordx4 v2, s[20:23], s47 offen offset:2048 lds
    buffer_load_dwordx4 v2, s[20:23], s48 offen offset:3072 lds
    s_waitcnt vmcnt(12)
    s_barrier
    s_add_u32 m0, s80, 90752
    v_add_u32 v5, 36864, v5
    buffer_load_dwordx4 v2, s[20:23], s49 offen lds
    buffer_load_dwordx4 v2, s[20:23], s50 offen offset:1024 lds
    buffer_load_dwordx4 v2, s[20:23], s51 offen offset:2048 lds
    buffer_load_dwordx4 v2, s[20:23], s52 offen offset:3072 lds
    s_add_u32 m0, s82, 86656
    s_nop 0
    buffer_load_dwordx4 v3, s[20:23], s53 offen lds
    s_waitcnt vmcnt(12)
    s_barrier
    s_bfm_b64 exec, 2, 0
    buffer_load_dword v12, v11, s[24:27], 0 offen
    s_bfm_b64 exec, 16, 0
    buffer_load_dword v13, v10, s[20:23], 0 offen
    s_mov_b64 exec, -1
    s_add_u32 m0, s81, 36864
    v_add_u32 v2, 0x80, v2
    buffer_load_dwordx4 v5, s[24:27], s55 offen lds
    buffer_load_dwordx4 v5, s[24:27], s56 offen offset:1024 lds
    buffer_load_dwordx4 v5, s[24:27], s57 offen offset:2048 lds
    s_waitcnt vmcnt(10)
    s_barrier
    s_add_u32 m0, s80, 124160
    v_add_u32 v3, 0x80, v3
    buffer_load_dwordx4 v2, s[20:23], s45 offen lds
    buffer_load_dwordx4 v2, s[20:23], s46 offen offset:1024 lds
    buffer_load_dwordx4 v2, s[20:23], s47 offen offset:2048 lds
    buffer_load_dwordx4 v2, s[20:23], s48 offen offset:3072 lds
    s_waitcnt vmcnt(9)
    s_barrier
    s_add_u32 m0, s80, 128256
    v_add_u32 v11, 73728, v11
    buffer_load_dwordx4 v2, s[20:23], s49 offen lds
    buffer_load_dwordx4 v2, s[20:23], s50 offen offset:1024 lds
    buffer_load_dwordx4 v2, s[20:23], s51 offen offset:2048 lds
    buffer_load_dwordx4 v2, s[20:23], s52 offen offset:3072 lds
    s_add_u32 m0, s82, 124160
    v_add_u32 v10, 128, v10
    buffer_load_dwordx4 v3, s[20:23], s53 offen lds
    s_add_u32 m0, s81, 0
    v_add_u32 v5, 36864, v5
    buffer_load_dwordx4 v5, s[24:27], s55 offen lds
    buffer_load_dwordx4 v5, s[24:27], s56 offen offset:1024 lds
    buffer_load_dwordx4 v5, s[24:27], s57 offen offset:2048 lds
    s_waitcnt vmcnt(12)
    s_barrier
    s_add_u32 m0, s81, 12288
    v_add_u32 v5, 36864, v5
    buffer_load_dwordx4 v5, s[24:27], s55 offen lds
    buffer_load_dwordx4 v5, s[24:27], s56 offen offset:1024 lds
    buffer_load_dwordx4 v5, s[24:27], s57 offen offset:2048 lds
    s_add_u32 m0, s81, 24576
    v_add_u32 v5, 36864, v5
    buffer_load_dwordx4 v5, s[24:27], s55 offen lds
    buffer_load_dwordx4 v5, s[24:27], s56 offen offset:1024 lds
    buffer_load_dwordx4 v5, s[24:27], s57 offen offset:2048 lds
    s_bfm_b64 exec, 16, 0
    buffer_load_dword v13, v10, s[20:23], 0 offen
    s_mov_b64 exec, -1
    v_add_u32 v10, 128, v10
    s_bfm_b64 exec, 12, 0
    buffer_load_dword v12, v11, s[24:27], 0 offen
    s_mov_b64 exec, -1
    s_waitcnt vmcnt(8)
    s_barrier
    s_add_u32 m0, s80, 49152
    v_add_u32 v2, 0x80, v2
    buffer_load_dwordx4 v2, s[20:23], s45 offen lds
    buffer_load_dwordx4 v2, s[20:23], s46 offen offset:1024 lds
    buffer_load_dwordx4 v2, s[20:23], s47 offen offset:2048 lds
    buffer_load_dwordx4 v2, s[20:23], s48 offen offset:3072 lds
    s_add_u32 m0, s80, 53248
    v_add_u32 v3, 0x80, v3
    buffer_load_dwordx4 v2, s[20:23], s49 offen lds
    buffer_load_dwordx4 v2, s[20:23], s50 offen offset:1024 lds
    buffer_load_dwordx4 v2, s[20:23], s51 offen offset:2048 lds
    buffer_load_dwordx4 v2, s[20:23], s52 offen offset:3072 lds
    s_add_u32 m0, s82, 49152
    v_add_u32 v5, 36864, v5
    buffer_load_dwordx4 v3, s[20:23], s53 offen lds
    s_waitcnt vmcnt(14)
    s_barrier
    s_add_u32 m0, s81, 36864
    v_add_u32 v11, 442368, v11
    buffer_load_dwordx4 v5, s[24:27], s55 offen lds
    buffer_load_dwordx4 v5, s[24:27], s56 offen offset:1024 lds
    buffer_load_dwordx4 v5, s[24:27], s57 offen offset:2048 lds
    s_add_u32 m0, s81, 0
    v_add_u32 v5, 36864, v5
    buffer_load_dwordx4 v5, s[24:27], s55 offen lds
    buffer_load_dwordx4 v5, s[24:27], s56 offen offset:1024 lds
    buffer_load_dwordx4 v5, s[24:27], s57 offen offset:2048 lds
    s_bfm_b64 exec, 32, 0
    buffer_load_dword v13, v10, s[20:23], 0 offen
    s_mov_b64 exec, -1
    s_waitcnt vmcnt(7)
    s_barrier
    s_add_u32 m0, s80, 86656
    v_add_u32 v2, 0x80, v2
    buffer_load_dwordx4 v2, s[20:23], s45 offen lds
    buffer_load_dwordx4 v2, s[20:23], s46 offen offset:1024 lds
    buffer_load_dwordx4 v2, s[20:23], s47 offen offset:2048 lds
    buffer_load_dwordx4 v2, s[20:23], s48 offen offset:3072 lds
    s_add_u32 m0, s80, 90752
    v_add_u32 v3, 0x80, v3
    buffer_load_dwordx4 v2, s[20:23], s49 offen lds
    buffer_load_dwordx4 v2, s[20:23], s50 offen offset:1024 lds
    buffer_load_dwordx4 v2, s[20:23], s51 offen offset:2048 lds
    buffer_load_dwordx4 v2, s[20:23], s52 offen offset:3072 lds
    s_add_u32 m0, s82, 86656
    v_add_u32 v5, 36864, v5
    buffer_load_dwordx4 v3, s[20:23], s53 offen lds
    s_waitcnt vmcnt(13)
    s_barrier
    s_lshl_b32 s3, s39, 7
    s_add_u32 s32, s3, 64
    s_waitcnt lgkmcnt(0)
    s_load_dword s86, s[8:9], s3
    s_load_dword s86, s[8:9], s32
    s_load_dword s87, s[10:11], s3
    s_load_dword s87, s[10:11], s32
    s_load_dword s88, s[12:13], s3
    s_load_dword s88, s[12:13], s32
    s_load_dword s89, s[14:15], s3
    s_load_dword s89, s[14:15], s32
    s_add_u32 m0, s81, 12288
    v_add_u32 v10, 256, v10
    buffer_load_dwordx4 v5, s[24:27], s55 offen lds
    buffer_load_dwordx4 v5, s[24:27], s56 offen offset:1024 lds
    buffer_load_dwordx4 v5, s[24:27], s57 offen offset:2048 lds
    s_add_u32 m0, s81, 24576
    v_add_u32 v5, 36864, v5
    buffer_load_dwordx4 v5, s[24:27], s55 offen lds
    buffer_load_dwordx4 v5, s[24:27], s56 offen offset:1024 lds
    buffer_load_dwordx4 v5, s[24:27], s57 offen offset:2048 lds
    s_bfm_b64 exec, 32, 0
    buffer_load_dword v13, v10, s[20:23], 0 offen
    s_mov_b64 exec, -1
    s_waitcnt vmcnt(7)
    s_barrier
    s_add_u32 m0, s80, 124160
    v_add_u32 v2, 0x80, v2
    buffer_load_dwordx4 v2, s[20:23], s45 offen lds
    buffer_load_dwordx4 v2, s[20:23], s46 offen offset:1024 lds
    buffer_load_dwordx4 v2, s[20:23], s47 offen offset:2048 lds
    buffer_load_dwordx4 v2, s[20:23], s48 offen offset:3072 lds
    s_add_u32 m0, s80, 128256
    v_add_u32 v3, 0x80, v3
    buffer_load_dwordx4 v2, s[20:23], s49 offen lds
    buffer_load_dwordx4 v2, s[20:23], s50 offen offset:1024 lds
    buffer_load_dwordx4 v2, s[20:23], s51 offen offset:2048 lds
    buffer_load_dwordx4 v2, s[20:23], s52 offen offset:3072 lds
    s_add_u32 m0, s82, 124160
    v_add_u32 v5, 36864, v5
    buffer_load_dwordx4 v3, s[20:23], s53 offen lds
    s_waitcnt vmcnt(13)
    s_barrier
    s_add_u32 m0, s81, 36864
    v_add_u32 v10, 256, v10
    buffer_load_dwordx4 v5, s[24:27], s55 offen lds
    buffer_load_dwordx4 v5, s[24:27], s56 offen offset:1024 lds
    buffer_load_dwordx4 v5, s[24:27], s57 offen offset:2048 lds
    s_add_u32 m0, s81, 0
    v_add_u32 v5, 36864, v5
    buffer_load_dwordx4 v5, s[24:27], s55 offen lds
    buffer_load_dwordx4 v5, s[24:27], s56 offen offset:1024 lds
    buffer_load_dwordx4 v5, s[24:27], s57 offen offset:2048 lds
    s_add_u32 m0, s80, 49152
    v_add_u32 v2, 0x80, v2
    buffer_load_dwordx4 v2, s[20:23], s45 offen lds
    buffer_load_dwordx4 v2, s[20:23], s46 offen offset:1024 lds
    buffer_load_dwordx4 v2, s[20:23], s47 offen offset:2048 lds
    buffer_load_dwordx4 v2, s[20:23], s48 offen offset:3072 lds
    s_bfm_b64 exec, 16, 0
    buffer_load_dword v13, v10, s[20:23], 0 offen
    s_mov_b64 exec, -1
    s_waitcnt vmcnt(11)
    s_barrier
    s_add_u32 m0, s80, 53248
    v_add_u32 v3, 0x80, v3
    buffer_load_dwordx4 v2, s[20:23], s49 offen lds
    buffer_load_dwordx4 v2, s[20:23], s50 offen offset:1024 lds
    buffer_load_dwordx4 v2, s[20:23], s51 offen offset:2048 lds
    buffer_load_dwordx4 v2, s[20:23], s52 offen offset:3072 lds
    s_add_u32 m0, s82, 49152
    v_add_u32 v5, 36864, v5
    buffer_load_dwordx4 v3, s[20:23], s53 offen lds
    s_add_u32 m0, s80, 86656
    v_add_u32 v2, 0x80, v2
    buffer_load_dwordx4 v2, s[20:23], s45 offen lds
    buffer_load_dwordx4 v2, s[20:23], s46 offen offset:1024 lds
    buffer_load_dwordx4 v2, s[20:23], s47 offen offset:2048 lds
    buffer_load_dwordx4 v2, s[20:23], s48 offen offset:3072 lds
    s_waitcnt vmcnt(17)
    s_barrier
    s_add_u32 m0, s81, 12288
    v_add_u32 v10, 128, v10
    buffer_load_dwordx4 v5, s[24:27], s55 offen lds
    buffer_load_dwordx4 v5, s[24:27], s56 offen offset:1024 lds
    buffer_load_dwordx4 v5, s[24:27], s57 offen offset:2048 lds
    s_add_u32 m0, s81, 24576
    v_add_u32 v5, 36864, v5
    buffer_load_dwordx4 v5, s[24:27], s55 offen lds
    buffer_load_dwordx4 v5, s[24:27], s56 offen offset:1024 lds
    buffer_load_dwordx4 v5, s[24:27], s57 offen offset:2048 lds
    s_add_u32 m0, s80, 90752
    v_add_u32 v3, 0x80, v3
    buffer_load_dwordx4 v2, s[20:23], s49 offen lds
    buffer_load_dwordx4 v2, s[20:23], s50 offen offset:1024 lds
    buffer_load_dwordx4 v2, s[20:23], s51 offen offset:2048 lds
    buffer_load_dwordx4 v2, s[20:23], s52 offen offset:3072 lds
    s_add_u32 m0, s82, 86656
    v_add_u32 v5, 36864, v5
    buffer_load_dwordx4 v3, s[20:23], s53 offen lds
    s_waitcnt vmcnt(15)
    s_barrier
    s_add_u32 m0, s81, 36864
    v_add_u32 v2, 0x80, v2
    buffer_load_dwordx4 v5, s[24:27], s55 offen lds
    buffer_load_dwordx4 v5, s[24:27], s56 offen offset:1024 lds
    buffer_load_dwordx4 v5, s[24:27], s57 offen offset:2048 lds
    s_add_u32 m0, s80, 124160
    v_add_u32 v3, 0x80, v3
    buffer_load_dwordx4 v2, s[20:23], s45 offen lds
    buffer_load_dwordx4 v2, s[20:23], s46 offen offset:1024 lds
    buffer_load_dwordx4 v2, s[20:23], s47 offen offset:2048 lds
    buffer_load_dwordx4 v2, s[20:23], s48 offen offset:3072 lds
    s_lshl_b32 s3, s39, 7
    v_lshl_add_u32 v20, v0, 1, s3
    s_waitcnt lgkmcnt(0)
    global_load_ushort v24, v20, s[8:9]
    global_load_ushort v25, v20, s[10:11]
    global_load_ushort v26, v20, s[12:13]
    global_load_ushort v27, v20, s[14:15]
    s_waitcnt vmcnt(19)
    s_barrier
    s_add_u32 m0, s81, 0
    v_add_u32 v5, 36864, v5
    buffer_load_dwordx4 v5, s[24:27], s55 offen lds
    buffer_load_dwordx4 v5, s[24:27], s56 offen offset:1024 lds
    buffer_load_dwordx4 v5, s[24:27], s57 offen offset:2048 lds
    s_add_u32 m0, s80, 128256
    v_add_u32 v5, 36864, v5
    buffer_load_dwordx4 v2, s[20:23], s49 offen lds
    buffer_load_dwordx4 v2, s[20:23], s50 offen offset:1024 lds
    buffer_load_dwordx4 v2, s[20:23], s51 offen offset:2048 lds
    buffer_load_dwordx4 v2, s[20:23], s52 offen offset:3072 lds
    s_add_u32 m0, s82, 124160
    s_nop 0
    buffer_load_dwordx4 v3, s[20:23], s53 offen lds
    s_waitcnt vmcnt(16)
    s_barrier
    s_add_u32 m0, s81, 12288
    s_nop 0
    buffer_load_dwordx4 v5, s[24:27], s55 offen lds
    buffer_load_dwordx4 v5, s[24:27], s56 offen offset:1024 lds
    buffer_load_dwordx4 v5, s[24:27], s57 offen offset:2048 lds
    s_waitcnt vmcnt(11)
    v_lshlrev_b32 v25, 16, v25
    v_add_f32 v25, 0x3727c5ac, v25
    v_cvt_pk_bf16_f32 v25, v25, v25
    v_lshlrev_b32 v25, 16, v25
    v_sqrt_f32 v25, v25
    v_lshlrev_b32 v26, 16, v26
    v_cvt_pk_bf16_f32 v25, v25, v25
    v_lshlrev_b32 v25, 16, v25
    v_rcp_f32 v25, v25
    v_lshlrev_b32 v24, 16, v24
    v_cvt_pk_bf16_f32 v25, v25, v25
    v_lshlrev_b32 v25, 16, v25
    v_mul_f32 v25, v25, v26
    v_cvt_pk_bf16_f32 v25, v25, v25
    v_lshlrev_b32 v25, 16, v25
    v_lshlrev_b32 v27, 16, v27
    v_fma_f32 v27, -v24, v25, v27
    v_mul_f32 v25, 0xbfb8aa3b, v25
    v_mul_f32 v27, 0xbfb8aa3b, v27
    s_lshl_b32 s3, s42, 9
    s_add_u32 s3, s3, 161664
    v_lshl_add_u32 v28, v0, 2, s3
    ds_write2st64_b32 v28, v25, v27 offset1:1
    s_waitcnt vmcnt(3)
    s_barrier
    s_waitcnt vmcnt(0)
    s_waitcnt lgkmcnt(0)
    s_barrier
    s_endpgm
L_ldend_n:
L_page1:
.fill ((3584 - (L_page1 - L_base)) & 4095) / 4, 4, 0xbf810000
L_cons:
    s_load_dwordx2 s[28:29], s[0:1], 48
    s_setprio 2
    s_getpc_b64 s[42:43]
L_pc:
    s_lshr_b32 s3, s2, 3
    s_lshl_b32 s3, s3, 2
    s_add_u32 s3, s3, s36
    s_mul_i32 s3, s3, 256
    s_min_u32 s3, s3, L_end-standalone__batchnorm__sampling_kernel-256
    s_sub_u32 s42, s42, L_pc-standalone__batchnorm__sampling_kernel
    s_subb_u32 s43, s43, 0
    s_add_u32 s42, s42, s3
    s_addc_u32 s43, s43, 0
    s_load_dword s44, s[42:43], 0
    s_load_dword s45, s[42:43], 64
    s_load_dword s46, s[42:43], 128
    s_load_dword s47, s[42:43], 192
    v_lshrrev_b32 v10, 4, v0
    v_and_b32 v11, 15, v0
    v_lshrrev_b32 v14, 1, v11
    v_xor_b32 v14, v14, v10
    v_lshlrev_b32 v14, 4, v14
    v_and_b32 v12, 7, v0
    v_lshl_add_u32 v14, v12, 7, v14
    v_bfe_u32 v13, v0, 3, 1
    v_bfe_u32 v16, v0, 2, 2
    v_and_b32 v17, 1, v10
    v_and_b32 v18, 3, v0
    s_cmp_ge_u32 s37, 252
    s_cbranch_scc1 L_cons_s
    s_lshr_b32 s56, s36, 1
    s_and_b32 s57, s36, 1
    v_mul_u32_u24 v13, 16384, v13
    s_lshl_b32 s3, s56, 13
    s_add_u32 s3, s3, 49152
    v_add3_u32 v5, v13, v14, s3
    v_lshrrev_b32 v20, 3, v0
    v_lshlrev_b32 v21, 4, v12
    s_mov_b32 s3, 81920
    v_mov_b32 v24, 0
    v_mov_b32 v25, 0
    v_mov_b32 v26, 0
    v_mov_b32 v27, 0
    v_mul_u32_u24 v22, 52, v20
    v_lshrrev_b32 v22, 8, v22
    v_mul_u32_u24 v22, 31744, v22
    v_mul_u32_u24 v23, 1152, v20
    v_add3_u32 v22, v22, v23, v21
    v_add_u32 v22, s3, v22
    ds_write_b128 v22, v[24:27]
    v_add_u32 v20, 8, v20
    v_min_u32 v20, 14, v20
    v_mul_u32_u24 v22, 52, v20
    v_lshrrev_b32 v22, 8, v22
    v_mul_u32_u24 v22, 31744, v22
    v_mul_u32_u24 v23, 1152, v20
    v_add3_u32 v22, v22, v23, v21
    v_add_u32 v22, s3, v22
    ds_write_b128 v22, v[24:27]
    v_lshrrev_b32 v20, 2, v11
    s_lshl_b32 s3, s56, 2
    v_or_b32 v21, s3, v18
    v_mul_u32_u24 v28, 9216, v20
    v_mul_u32_u24 v29, 1152, v18
    v_add_u32 v28, v28, v29
    v_bfe_u32 v22, v21, 1, 1
    v_lshl_or_b32 v22, v20, 1, v22
    v_xor_b32 v22, v22, v10
    v_lshlrev_b32 v22, 4, v22
    v_mad_u32_u24 v23, v20, 9, v21
    v_lshl_add_u32 v22, v23, 7, v22
    v_add_u32 v30, 81920, v22
    v_add_u32 v21, 1, v21
    v_bfe_u32 v22, v21, 1, 1
    v_lshl_or_b32 v22, v20, 1, v22
    v_xor_b32 v22, v22, v10
    v_lshlrev_b32 v22, 4, v22
    v_mad_u32_u24 v23, v20, 9, v21
    v_lshl_add_u32 v22, v23, 7, v22
    v_add_u32 v31, 81920, v22
    v_lshrrev_b32 v14, 1, v16
    v_lshl_or_b32 v14, v17, 1, v14
    s_lshl_b32 s3, s57, 1
    v_xor_b32 v14, s3, v14
    v_lshlrev_b32 v14, 5, v14
    v_lshl_add_u32 v14, v16, 7, v14
    v_lshl_add_u32 v14, v18, 3, v14
    v_mul_u32_u24 v15, 3072, v10
    v_add_u32 v6, v14, v15
    v_mul_u32_u24 v14, 9216, v11
    v_lshrrev_b32 v15, 1, v10
    v_lshl_add_u32 v19, v15, 4, v14
    v_lshl_add_u32 v7, v17, 5, v19
    s_lshl_b32 s32, s57, 6
    s_lshl_b32 s3, s39, 7
    s_add_u32 s32, s32, s3
    s_mul_i32 s3, s40, 1327104
    s_add_u32 s32, s32, s3
    s_lshl_b32 s3, s41, 1
    s_add_u32 s3, s3, s56
    s_mul_i32 s33, s3, 147456
    s_add_u32 s86, s33, s32
    s_mul_i32 s33, s41, 36864
    s_add_u32 s33, s33, s32
    s_mul_i32 s3, s56, 4608
    s_add_u32 s33, s33, s3
    s_add_u32 s94, s33, 1179648
    s_add_u32 s87, s86, 1152
    s_add_u32 s88, s86, 2304
    s_add_u32 s89, s86, 3456
    s_add_u32 s90, s86, 4608
    s_add_u32 s91, s86, 5760
    s_add_u32 s92, s86, 6912
    s_add_u32 s93, s86, 8064
    s_mov_b32 s84, 0xbfb8aa3b
    s_mov_b32 s85, 0xbfb8aa3b
    s_lshl_b32 s3, s57, 7
    s_add_u32 s3, s3, 161664
    v_lshl_add_u32 v8, v10, 4, s3
    v_lshrrev_b32 v15, 1, v10
    v_lshl_add_u32 v28, v15, 4, v28
    v_lshl_add_u32 v13, v17, 5, v28
    v_mov_b32 v11, v30
    v_mov_b32 v12, v31
    v_mov_b32 v2, v30
    v_mov_b32 v9, v31
    v_xor_b32 v10, 16, v30
    v_mov_b32 v1, v5
    v_mov_b32 v3, v6
    v_xor_b32 v4, 32, v6
    s_mov_b32 s59, 0
    s_mov_b32 s80, 0
    s_mov_b32 s81, 6
    s_mov_b32 s30, 9437184
    s_mov_b32 s31, 0x20000
    s_waitcnt lgkmcnt(0)
    s_branch L_stub_n
L_back_n:
    v_xor_b32 v240, 64, v1
    s_barrier
    ds_read_b64_tr_b16 v[96:97], v3 offset:1024
    ds_read_b64_tr_b16 v[98:99], v3 offset:1536
    ds_read_b64_tr_b16 v[104:105], v3 offset:2048
    ds_read_b64_tr_b16 v[106:107], v3 offset:2560
    ds_read_b64_tr_b16 v[108:109], v4 offset:2048
    ds_read_b64_tr_b16 v[110:111], v4 offset:2560
    ds_read_b64_tr_b16 v[100:101], v4 offset:1024
    ds_read_b64_tr_b16 v[102:103], v4 offset:1536
    ds_read_b64_tr_b16 v[88:89], v3 offset:0
    ds_read_b64_tr_b16 v[90:91], v3 offset:512
    ds_read_b64_tr_b16 v[92:93], v4 offset:0
    ds_read_b64_tr_b16 v[94:95], v4 offset:512
    s_barrier
    ds_read_b128 v[136:139], v1 offset:0
    ds_read_b128 v[140:143], v1 offset:1024
    ds_read_b128 v[144:147], v1 offset:2048
    s_waitcnt lgkmcnt(2)
    v_mfma_f32_16x16x32_bf16 v[16:19], v[96:99], v[136:139], 0
    s_waitcnt lgkmcnt(1)
    ds_read_b128 v[148:151], v1 offset:3072
    s_mov_b32 s80, 24576
    v_mfma_f32_16x16x32_bf16 v[16:19], v[104:107], v[140:143], v[16:19]
    ds_read_b128 v[168:171], v240 offset:0
    v_mfma_f32_16x16x32_bf16 v[20:23], v[108:111], v[140:143], 0
    ds_read_b128 v[172:175], v240 offset:1024
    v_mfma_f32_16x16x32_bf16 v[20:23], v[100:103], v[136:139], v[20:23]
    ds_read_b128 v[176:179], v240 offset:2048
    v_mfma_f32_16x16x32_bf16 v[24:27], v[88:91], v[136:139], 0
    ds_read_b128 v[180:183], v240 offset:3072
    v_mfma_f32_16x16x32_bf16 v[24:27], v[96:99], v[140:143], v[24:27]
    s_waitcnt lgkmcnt(5)
    v_mfma_f32_16x16x32_bf16 v[24:27], v[104:107], v[144:147], v[24:27]
    v_mfma_f32_16x16x32_bf16 v[28:31], v[108:111], v[144:147], 0
    v_mfma_f32_16x16x32_bf16 v[28:31], v[100:103], v[140:143], v[28:31]
    v_mfma_f32_16x16x32_bf16 v[28:31], v[92:95], v[136:139], v[28:31]
    s_barrier
    ds_read_b64_tr_b16 v[120:121], v3 offset:13312
    ds_read_b64_tr_b16 v[122:123], v3 offset:13824
    v_mfma_f32_16x16x32_bf16 v[32:35], v[88:91], v[140:143], 0
    ds_read_b64_tr_b16 v[128:129], v3 offset:14336
    ds_read_b64_tr_b16 v[130:131], v3 offset:14848
    v_mfma_f32_16x16x32_bf16 v[32:35], v[96:99], v[144:147], v[32:35]
    s_waitcnt lgkmcnt(4)
    ds_read_b64_tr_b16 v[132:133], v4 offset:14336
    ds_read_b64_tr_b16 v[134:135], v4 offset:14848
    v_mfma_f32_16x16x32_bf16 v[32:35], v[104:107], v[148:151], v[32:35]
    ds_read_b64_tr_b16 v[124:125], v4 offset:13312
    ds_read_b64_tr_b16 v[126:127], v4 offset:13824
    v_mfma_f32_16x16x32_bf16 v[36:39], v[108:111], v[148:151], 0
    ds_read_b64_tr_b16 v[112:113], v3 offset:12288
    ds_read_b64_tr_b16 v[114:115], v3 offset:12800
    v_mfma_f32_16x16x32_bf16 v[36:39], v[100:103], v[144:147], v[36:39]
    ds_read_b64_tr_b16 v[116:117], v4 offset:12288
    ds_read_b64_tr_b16 v[118:119], v4 offset:12800
    v_mfma_f32_16x16x32_bf16 v[36:39], v[92:95], v[140:143], v[36:39]
    v_mfma_f32_16x16x32_bf16 v[40:43], v[88:91], v[144:147], 0
    v_mfma_f32_16x16x32_bf16 v[40:43], v[96:99], v[148:151], v[40:43]
    v_mfma_f32_16x16x32_bf16 v[44:47], v[100:103], v[148:151], 0
    v_mfma_f32_16x16x32_bf16 v[44:47], v[92:95], v[144:147], v[44:47]
    s_waitcnt lgkmcnt(2)
    v_mfma_f32_16x16x32_bf16 v[16:19], v[120:123], v[168:171], v[16:19]
    v_mfma_f32_16x16x32_bf16 v[16:19], v[128:131], v[172:175], v[16:19]
    v_mfma_f32_16x16x32_bf16 v[20:23], v[132:135], v[172:175], v[20:23]
    v_mfma_f32_16x16x32_bf16 v[20:23], v[124:127], v[168:171], v[20:23]
    v_mfma_f32_16x16x32_bf16 v[24:27], v[112:115], v[168:171], v[24:27]
    v_mfma_f32_16x16x32_bf16 v[24:27], v[120:123], v[172:175], v[24:27]
    v_mfma_f32_16x16x32_bf16 v[24:27], v[128:131], v[176:179], v[24:27]
    v_mfma_f32_16x16x32_bf16 v[28:31], v[132:135], v[176:179], v[28:31]
    v_mfma_f32_16x16x32_bf16 v[28:31], v[124:127], v[172:175], v[28:31]
    s_waitcnt lgkmcnt(0)
    v_mfma_f32_16x16x32_bf16 v[28:31], v[116:119], v[168:171], v[28:31]
    v_mfma_f32_16x16x32_bf16 v[32:35], v[112:115], v[172:175], v[32:35]
    v_mfma_f32_16x16x32_bf16 v[32:35], v[120:123], v[176:179], v[32:35]
    v_mfma_f32_16x16x32_bf16 v[32:35], v[128:131], v[180:183], v[32:35]
    s_barrier
    ds_read_b128 v[200:203], v2 offset:0
    v_mfma_f32_16x16x32_bf16 v[36:39], v[132:135], v[180:183], v[36:39]
    ds_read_b128 v[204:207], v9 offset:0
    v_mfma_f32_16x16x32_bf16 v[36:39], v[124:127], v[176:179], v[36:39]
    ds_read_b128 v[208:211], v10 offset:256
    v_xor_b32 v2, 64, v2
    v_mfma_f32_16x16x32_bf16 v[36:39], v[116:119], v[172:175], v[36:39]
    ds_read_b128 v[152:155], v1 offset:4096
    v_xor_b32 v9, 64, v9
    v_mfma_f32_16x16x32_bf16 v[40:43], v[112:115], v[176:179], v[40:43]
    ds_read_b128 v[156:159], v1 offset:5120
    v_xor_b32 v10, 64, v10
    v_mfma_f32_16x16x32_bf16 v[40:43], v[120:123], v[180:183], v[40:43]
    ds_read_b128 v[160:163], v1 offset:6144
    v_mfma_f32_16x16x32_bf16 v[44:47], v[124:127], v[180:183], v[44:47]
    ds_read_b128 v[164:167], v1 offset:7168
    v_mfma_f32_16x16x32_bf16 v[44:47], v[116:119], v[176:179], v[44:47]
    s_waitcnt lgkmcnt(5)
    ds_read_b128 v[184:187], v240 offset:4096
    v_mfma_f32_16x16x32_bf16 v[80:83], v[88:91], v[200:203], 0
    ds_read_b128 v[188:191], v240 offset:5120
    v_mfma_f32_16x16x32_bf16 v[80:83], v[96:99], v[204:207], v[80:83]
    s_waitcnt lgkmcnt(5)
    ds_read_b128 v[192:195], v240 offset:6144
    v_mfma_f32_16x16x32_bf16 v[80:83], v[104:107], v[208:211], v[80:83]
    ds_read_b128 v[196:199], v240 offset:7168
    v_mfma_f32_16x16x32_bf16 v[84:87], v[108:111], v[208:211], 0
    ds_read_b128 v[208:211], v10 offset:256
    v_mfma_f32_16x16x32_bf16 v[84:87], v[100:103], v[204:207], v[84:87]
    ds_read_b128 v[204:207], v9 offset:0
    v_mfma_f32_16x16x32_bf16 v[84:87], v[92:95], v[200:203], v[84:87]
    ds_read_b128 v[200:203], v2 offset:0
    s_mov_b32 s59, 37504
    v_mfma_f32_16x16x32_bf16 v[40:43], v[104:107], v[152:155], v[40:43]
    v_add_u32 v2, s59, v11
    v_add_u32 v9, s59, v12
    v_mfma_f32_16x16x32_bf16 v[44:47], v[108:111], v[152:155], v[44:47]
    v_xor_b32 v10, 16, v2
    v_mfma_f32_16x16x32_bf16 v[48:51], v[88:91], v[148:151], 0
    v_mfma_f32_16x16x32_bf16 v[48:51], v[96:99], v[152:155], v[48:51]
    s_waitcnt lgkmcnt(2)
    v_mfma_f32_16x16x32_bf16 v[48:51], v[104:107], v[156:159], v[48:51]
    v_mfma_f32_16x16x32_bf16 v[52:55], v[108:111], v[156:159], 0
    v_mfma_f32_16x16x32_bf16 v[52:55], v[100:103], v[152:155], v[52:55]
    v_mfma_f32_16x16x32_bf16 v[52:55], v[92:95], v[148:151], v[52:55]
    v_mfma_f32_16x16x32_bf16 v[56:59], v[88:91], v[152:155], 0
    v_mfma_f32_16x16x32_bf16 v[56:59], v[96:99], v[156:159], v[56:59]
    v_mfma_f32_16x16x32_bf16 v[56:59], v[104:107], v[160:163], v[56:59]
    v_mfma_f32_16x16x32_bf16 v[60:63], v[108:111], v[160:163], 0
    v_mfma_f32_16x16x32_bf16 v[60:63], v[100:103], v[156:159], v[60:63]
    v_mfma_f32_16x16x32_bf16 v[60:63], v[92:95], v[152:155], v[60:63]
    v_mfma_f32_16x16x32_bf16 v[64:67], v[88:91], v[156:159], 0
    v_mfma_f32_16x16x32_bf16 v[64:67], v[96:99], v[160:163], v[64:67]
    v_mfma_f32_16x16x32_bf16 v[64:67], v[104:107], v[164:167], v[64:67]
    v_mfma_f32_16x16x32_bf16 v[68:71], v[108:111], v[164:167], 0
    v_mfma_f32_16x16x32_bf16 v[68:71], v[100:103], v[160:163], v[68:71]
    v_mfma_f32_16x16x32_bf16 v[68:71], v[92:95], v[156:159], v[68:71]
    v_mfma_f32_16x16x32_bf16 v[72:75], v[88:91], v[160:163], 0
    v_mfma_f32_16x16x32_bf16 v[72:75], v[96:99], v[164:167], v[72:75]
    v_mfma_f32_16x16x32_bf16 v[76:79], v[100:103], v[164:167], 0
    v_mfma_f32_16x16x32_bf16 v[76:79], v[92:95], v[160:163], v[76:79]
    s_waitcnt lgkmcnt(0)
    v_mfma_f32_16x16x32_bf16 v[80:83], v[112:115], v[200:203], v[80:83]
    v_mfma_f32_16x16x32_bf16 v[80:83], v[120:123], v[204:207], v[80:83]
    v_mfma_f32_16x16x32_bf16 v[80:83], v[128:131], v[208:211], v[80:83]
    v_mfma_f32_16x16x32_bf16 v[84:87], v[132:135], v[208:211], v[84:87]
    v_mfma_f32_16x16x32_bf16 v[84:87], v[124:127], v[204:207], v[84:87]
    v_mfma_f32_16x16x32_bf16 v[84:87], v[116:119], v[200:203], v[84:87]
    s_barrier
    ds_read_b64_tr_b16 v[88:89], v3 offset:24576
    ds_read_b64_tr_b16 v[90:91], v3 offset:25088
    v_mfma_f32_16x16x32_bf16 v[40:43], v[128:131], v[184:187], v[40:43]
    ds_read_b64_tr_b16 v[96:97], v3 offset:25600
    ds_read_b64_tr_b16 v[98:99], v3 offset:26112
    v_mfma_f32_16x16x32_bf16 v[44:47], v[132:135], v[184:187], v[44:47]
    ds_read_b64_tr_b16 v[104:105], v3 offset:26624
    ds_read_b64_tr_b16 v[106:107], v3 offset:27136
    v_mfma_f32_16x16x32_bf16 v[48:51], v[112:115], v[180:183], v[48:51]
    ds_read_b64_tr_b16 v[108:109], v4 offset:26624
    ds_read_b64_tr_b16 v[110:111], v4 offset:27136
    v_mfma_f32_16x16x32_bf16 v[48:51], v[120:123], v[184:187], v[48:51]
    ds_read_b64_tr_b16 v[100:101], v4 offset:25600
    ds_read_b64_tr_b16 v[102:103], v4 offset:26112
    v_mfma_f32_16x16x32_bf16 v[48:51], v[128:131], v[188:191], v[48:51]
    ds_read_b64_tr_b16 v[92:93], v4 offset:24576
    ds_read_b64_tr_b16 v[94:95], v4 offset:25088
    v_mfma_f32_16x16x32_bf16 v[52:55], v[132:135], v[188:191], v[52:55]
    ds_read_b128 v[136:139], v1 offset:37504
    v_mfma_f32_16x16x32_bf16 v[52:55], v[124:127], v[184:187], v[52:55]
    ds_read_b128 v[140:143], v1 offset:38528
    v_mfma_f32_16x16x32_bf16 v[52:55], v[116:119], v[180:183], v[52:55]
    ds_read_b128 v[144:147], v1 offset:39552
    v_mfma_f32_16x16x32_bf16 v[56:59], v[112:115], v[184:187], v[56:59]
    ds_read_b128 v[148:151], v1 offset:40576
    v_mfma_f32_16x16x32_bf16 v[56:59], v[120:123], v[188:191], v[56:59]
    v_mfma_f32_16x16x32_bf16 v[56:59], v[128:131], v[192:195], v[56:59]
    v_mfma_f32_16x16x32_bf16 v[60:63], v[132:135], v[192:195], v[60:63]
    v_mfma_f32_16x16x32_bf16 v[60:63], v[124:127], v[188:191], v[60:63]
    v_mfma_f32_16x16x32_bf16 v[60:63], v[116:119], v[184:187], v[60:63]
    v_mfma_f32_16x16x32_bf16 v[64:67], v[112:115], v[188:191], v[64:67]
    v_mfma_f32_16x16x32_bf16 v[64:67], v[120:123], v[192:195], v[64:67]
    s_barrier
    ds_read_b128 v[200:203], v2 offset:0
    v_mfma_f32_16x16x32_bf16 v[64:67], v[128:131], v[196:199], v[64:67]
    ds_read_b128 v[204:207], v9 offset:0
    v_mfma_f32_16x16x32_bf16 v[68:71], v[132:135], v[196:199], v[68:71]
    ds_read_b128 v[208:211], v10 offset:256
    v_mfma_f32_16x16x32_bf16 v[68:71], v[124:127], v[192:195], v[68:71]
    ds_read_b128 v[152:155], v1 offset:41600
    v_mfma_f32_16x16x32_bf16 v[68:71], v[116:119], v[188:191], v[68:71]
    ds_read_b128 v[156:159], v1 offset:42624
    v_mfma_f32_16x16x32_bf16 v[72:75], v[112:115], v[192:195], v[72:75]
    ds_read_b128 v[160:163], v1 offset:43648
    v_mfma_f32_16x16x32_bf16 v[72:75], v[120:123], v[196:199], v[72:75]
    ds_read_b128 v[164:167], v1 offset:44672
    v_add_u32 v1, 37504, v1
    v_mfma_f32_16x16x32_bf16 v[76:79], v[124:127], v[196:199], v[76:79]
    s_waitcnt lgkmcnt(4)
    v_mfma_f32_16x16x32_bf16 v[76:79], v[116:119], v[192:195], v[76:79]
    s_branch L_cmid_n
.p2align 6
L_cloop_n:
    v_mfma_f32_16x16x32_bf16 v[80:83], v[112:115], v[200:203], v[80:83]
    s_add_u32 s80, s80, 12288
    s_cmp_eq_u32 s80, 49152
    v_mfma_f32_16x16x32_bf16 v[80:83], v[120:123], v[204:207], v[80:83]
    s_cselect_b32 s80, 0, s80
    v_add_u32 v3, s80, v6
    v_mfma_f32_16x16x32_bf16 v[80:83], v[128:131], v[208:211], v[80:83]
    v_xor_b32 v4, 32, v3
    s_add_u32 s59, s59, 37504
    v_mfma_f32_16x16x32_bf16 v[84:87], v[132:135], v[208:211], v[84:87]
    s_cmp_eq_u32 s59, 112512
    s_cselect_b32 s59, 0, s59
    v_mfma_f32_16x16x32_bf16 v[84:87], v[124:127], v[204:207], v[84:87]
    v_add_u32 v1, s59, v5
    v_add_u32 v2, s59, v11
    v_mfma_f32_16x16x32_bf16 v[84:87], v[116:119], v[200:203], v[84:87]
    v_add_u32 v9, s59, v12
    v_xor_b32 v10, 16, v2
    v_mfma_f32_16x16x32_bf16 v[16:19], v[120:123], v[168:171], v[16:19]
    v_mfma_f32_16x16x32_bf16 v[16:19], v[128:131], v[172:175], v[16:19]
    v_mfma_f32_16x16x32_bf16 v[20:23], v[132:135], v[172:175], v[20:23]
    v_mfma_f32_16x16x32_bf16 v[20:23], v[124:127], v[168:171], v[20:23]
    v_mfma_f32_16x16x32_bf16 v[24:27], v[112:115], v[168:171], v[24:27]
    v_mfma_f32_16x16x32_bf16 v[24:27], v[120:123], v[172:175], v[24:27]
    s_waitcnt lgkmcnt(0)
    v_mfma_f32_16x16x32_bf16 v[24:27], v[128:131], v[176:179], v[24:27]
    v_mfma_f32_16x16x32_bf16 v[28:31], v[132:135], v[176:179], v[28:31]
    v_mfma_f32_16x16x32_bf16 v[28:31], v[124:127], v[172:175], v[28:31]
    v_mfma_f32_16x16x32_bf16 v[28:31], v[116:119], v[168:171], v[28:31]
    v_mfma_f32_16x16x32_bf16 v[32:35], v[112:115], v[172:175], v[32:35]
    v_mfma_f32_16x16x32_bf16 v[32:35], v[120:123], v[176:179], v[32:35]
    v_mfma_f32_16x16x32_bf16 v[32:35], v[128:131], v[180:183], v[32:35]
    v_mfma_f32_16x16x32_bf16 v[36:39], v[132:135], v[180:183], v[36:39]
    v_mfma_f32_16x16x32_bf16 v[36:39], v[124:127], v[176:179], v[36:39]
    v_mfma_f32_16x16x32_bf16 v[36:39], v[116:119], v[172:175], v[36:39]
    s_barrier
    v_mfma_f32_16x16x32_bf16 v[40:43], v[112:115], v[176:179], v[40:43]
    ds_read_b64_tr_b16 v[88:89], v3 offset:0
    v_mfma_f32_16x16x32_bf16 v[40:43], v[120:123], v[180:183], v[40:43]
    ds_read_b64_tr_b16 v[90:91], v3 offset:512
    v_mfma_f32_16x16x32_bf16 v[40:43], v[128:131], v[184:187], v[40:43]
    ds_read_b128 v[136:139], v1 offset:0
    v_mfma_f32_16x16x32_bf16 v[44:47], v[132:135], v[184:187], v[44:47]
    ds_read_b64_tr_b16 v[96:97], v3 offset:1024
    v_mfma_f32_16x16x32_bf16 v[44:47], v[124:127], v[180:183], v[44:47]
    ds_read_b64_tr_b16 v[98:99], v3 offset:1536
    v_mfma_f32_16x16x32_bf16 v[44:47], v[116:119], v[176:179], v[44:47]
    ds_read_b128 v[140:143], v1 offset:1024
    v_mfma_f32_16x16x32_bf16 v[48:51], v[112:115], v[180:183], v[48:51]
    v_mfma_f32_16x16x32_bf16 v[48:51], v[120:123], v[184:187], v[48:51]
    ds_read_b64_tr_b16 v[104:105], v3 offset:2048
    v_mfma_f32_16x16x32_bf16 v[48:51], v[128:131], v[188:191], v[48:51]
    ds_read_b64_tr_b16 v[106:107], v3 offset:2560
    v_mfma_f32_16x16x32_bf16 v[52:55], v[132:135], v[188:191], v[52:55]
    ds_read_b128 v[144:147], v1 offset:2048
    v_mfma_f32_16x16x32_bf16 v[52:55], v[124:127], v[184:187], v[52:55]
    ds_read_b64_tr_b16 v[92:93], v4 offset:0
    v_mfma_f32_16x16x32_bf16 v[52:55], v[116:119], v[180:183], v[52:55]
    ds_read_b64_tr_b16 v[94:95], v4 offset:512
    v_mfma_f32_16x16x32_bf16 v[56:59], v[112:115], v[184:187], v[56:59]
    ds_read_b128 v[200:203], v2 offset:0
    v_mfma_f32_16x16x32_bf16 v[56:59], v[120:123], v[188:191], v[56:59]
    v_mfma_f32_16x16x32_bf16 v[56:59], v[128:131], v[192:195], v[56:59]
    ds_read_b64_tr_b16 v[100:101], v4 offset:1024
    v_mfma_f32_16x16x32_bf16 v[60:63], v[132:135], v[192:195], v[60:63]
    ds_read_b64_tr_b16 v[102:103], v4 offset:1536
    v_mfma_f32_16x16x32_bf16 v[60:63], v[124:127], v[188:191], v[60:63]
    ds_read_b128 v[204:207], v9 offset:0
    v_mfma_f32_16x16x32_bf16 v[60:63], v[116:119], v[184:187], v[60:63]
    ds_read_b64_tr_b16 v[108:109], v4 offset:2048
    v_mfma_f32_16x16x32_bf16 v[64:67], v[112:115], v[188:191], v[64:67]
    ds_read_b64_tr_b16 v[110:111], v4 offset:2560
    v_mfma_f32_16x16x32_bf16 v[64:67], v[120:123], v[192:195], v[64:67]
    ds_read_b128 v[208:211], v10 offset:256
    v_mfma_f32_16x16x32_bf16 v[64:67], v[128:131], v[196:199], v[64:67]
    v_mfma_f32_16x16x32_bf16 v[68:71], v[132:135], v[196:199], v[68:71]
    ds_read_b128 v[148:151], v1 offset:3072
    v_mfma_f32_16x16x32_bf16 v[68:71], v[124:127], v[192:195], v[68:71]
    ds_read_b128 v[152:155], v1 offset:4096
    v_mfma_f32_16x16x32_bf16 v[68:71], v[116:119], v[188:191], v[68:71]
    ds_read_b128 v[156:159], v1 offset:5120
    v_mfma_f32_16x16x32_bf16 v[72:75], v[112:115], v[192:195], v[72:75]
    ds_read_b128 v[160:163], v1 offset:6144
    v_mfma_f32_16x16x32_bf16 v[72:75], v[120:123], v[196:199], v[72:75]
    ds_read_b128 v[164:167], v1 offset:7168
    v_mfma_f32_16x16x32_bf16 v[76:79], v[124:127], v[196:199], v[76:79]
    s_waitcnt lgkmcnt(5)
    v_mfma_f32_16x16x32_bf16 v[76:79], v[116:119], v[192:195], v[76:79]
L_cmid_n:
    v_mfma_f32_16x16x32_bf16 v[80:83], v[88:91], v[200:203], v[80:83]
    s_add_u32 s80, s80, 12288
    s_cmp_eq_u32 s80, 49152
    v_mfma_f32_16x16x32_bf16 v[80:83], v[96:99], v[204:207], v[80:83]
    s_cselect_b32 s80, 0, s80
    v_add_u32 v3, s80, v6
    v_mfma_f32_16x16x32_bf16 v[80:83], v[104:107], v[208:211], v[80:83]
    v_xor_b32 v4, 32, v3
    v_xor_b32 v1, 64, v1
    v_mfma_f32_16x16x32_bf16 v[84:87], v[108:111], v[208:211], v[84:87]
    v_xor_b32 v2, 64, v2
    v_xor_b32 v9, 64, v9
    v_mfma_f32_16x16x32_bf16 v[84:87], v[100:103], v[204:207], v[84:87]
    v_xor_b32 v10, 64, v10
    s_sub_u32 s81, s81, 1
    v_mfma_f32_16x16x32_bf16 v[84:87], v[92:95], v[200:203], v[84:87]
    s_cmp_lg_u32 s81, 0
    v_mfma_f32_16x16x32_bf16 v[16:19], v[96:99], v[136:139], v[16:19]
    v_mfma_f32_16x16x32_bf16 v[16:19], v[104:107], v[140:143], v[16:19]
    v_mfma_f32_16x16x32_bf16 v[20:23], v[108:111], v[140:143], v[20:23]
    v_mfma_f32_16x16x32_bf16 v[20:23], v[100:103], v[136:139], v[20:23]
    v_mfma_f32_16x16x32_bf16 v[24:27], v[88:91], v[136:139], v[24:27]
    v_mfma_f32_16x16x32_bf16 v[24:27], v[96:99], v[140:143], v[24:27]
    s_waitcnt lgkmcnt(0)
    v_mfma_f32_16x16x32_bf16 v[24:27], v[104:107], v[144:147], v[24:27]
    v_mfma_f32_16x16x32_bf16 v[28:31], v[108:111], v[144:147], v[28:31]
    v_mfma_f32_16x16x32_bf16 v[28:31], v[100:103], v[140:143], v[28:31]
    v_mfma_f32_16x16x32_bf16 v[28:31], v[92:95], v[136:139], v[28:31]
    v_mfma_f32_16x16x32_bf16 v[32:35], v[88:91], v[140:143], v[32:35]
    v_mfma_f32_16x16x32_bf16 v[32:35], v[96:99], v[144:147], v[32:35]
    v_mfma_f32_16x16x32_bf16 v[32:35], v[104:107], v[148:151], v[32:35]
    v_mfma_f32_16x16x32_bf16 v[36:39], v[108:111], v[148:151], v[36:39]
    v_mfma_f32_16x16x32_bf16 v[36:39], v[100:103], v[144:147], v[36:39]
    v_mfma_f32_16x16x32_bf16 v[36:39], v[92:95], v[140:143], v[36:39]
    s_barrier
    v_mfma_f32_16x16x32_bf16 v[40:43], v[88:91], v[144:147], v[40:43]
    ds_read_b64_tr_b16 v[112:113], v3 offset:0
    v_mfma_f32_16x16x32_bf16 v[40:43], v[96:99], v[148:151], v[40:43]
    ds_read_b64_tr_b16 v[114:115], v3 offset:512
    v_mfma_f32_16x16x32_bf16 v[40:43], v[104:107], v[152:155], v[40:43]
    ds_read_b128 v[168:171], v1 offset:0
    v_mfma_f32_16x16x32_bf16 v[44:47], v[108:111], v[152:155], v[44:47]
    ds_read_b64_tr_b16 v[120:121], v3 offset:1024
    v_mfma_f32_16x16x32_bf16 v[44:47], v[100:103], v[148:151], v[44:47]
    ds_read_b64_tr_b16 v[122:123], v3 offset:1536
    v_mfma_f32_16x16x32_bf16 v[44:47], v[92:95], v[144:147], v[44:47]
    ds_read_b128 v[172:175], v1 offset:1024
    v_mfma_f32_16x16x32_bf16 v[48:51], v[88:91], v[148:151], v[48:51]
    v_mfma_f32_16x16x32_bf16 v[48:51], v[96:99], v[152:155], v[48:51]
    ds_read_b64_tr_b16 v[128:129], v3 offset:2048
    v_mfma_f32_16x16x32_bf16 v[48:51], v[104:107], v[156:159], v[48:51]
    ds_read_b64_tr_b16 v[130:131], v3 offset:2560
    v_mfma_f32_16x16x32_bf16 v[52:55], v[108:111], v[156:159], v[52:55]
    ds_read_b128 v[176:179], v1 offset:2048
    v_mfma_f32_16x16x32_bf16 v[52:55], v[100:103], v[152:155], v[52:55]
    ds_read_b64_tr_b16 v[116:117], v4 offset:0
    v_mfma_f32_16x16x32_bf16 v[52:55], v[92:95], v[148:151], v[52:55]
    ds_read_b64_tr_b16 v[118:119], v4 offset:512
    v_mfma_f32_16x16x32_bf16 v[56:59], v[88:91], v[152:155], v[56:59]
    ds_read_b128 v[200:203], v2 offset:0
    v_mfma_f32_16x16x32_bf16 v[56:59], v[96:99], v[156:159], v[56:59]
    v_mfma_f32_16x16x32_bf16 v[56:59], v[104:107], v[160:163], v[56:59]
    ds_read_b64_tr_b16 v[124:125], v4 offset:1024
    v_mfma_f32_16x16x32_bf16 v[60:63], v[108:111], v[160:163], v[60:63]
    ds_read_b64_tr_b16 v[126:127], v4 offset:1536
    v_mfma_f32_16x16x32_bf16 v[60:63], v[100:103], v[156:159], v[60:63]
    ds_read_b128 v[204:207], v9 offset:0
    v_mfma_f32_16x16x32_bf16 v[60:63], v[92:95], v[152:155], v[60:63]
    ds_read_b64_tr_b16 v[132:133], v4 offset:2048
    v_mfma_f32_16x16x32_bf16 v[64:67], v[88:91], v[156:159], v[64:67]
    ds_read_b64_tr_b16 v[134:135], v4 offset:2560
    v_mfma_f32_16x16x32_bf16 v[64:67], v[96:99], v[160:163], v[64:67]
    ds_read_b128 v[208:211], v10 offset:256
    v_mfma_f32_16x16x32_bf16 v[64:67], v[104:107], v[164:167], v[64:67]
    v_mfma_f32_16x16x32_bf16 v[68:71], v[108:111], v[164:167], v[68:71]
    ds_read_b128 v[180:183], v1 offset:3072
    v_mfma_f32_16x16x32_bf16 v[68:71], v[100:103], v[160:163], v[68:71]
    ds_read_b128 v[184:187], v1 offset:4096
    v_mfma_f32_16x16x32_bf16 v[68:71], v[92:95], v[156:159], v[68:71]
    ds_read_b128 v[188:191], v1 offset:5120
    v_mfma_f32_16x16x32_bf16 v[72:75], v[88:91], v[160:163], v[72:75]
    ds_read_b128 v[192:195], v1 offset:6144
    v_mfma_f32_16x16x32_bf16 v[72:75], v[96:99], v[164:167], v[72:75]
    ds_read_b128 v[196:199], v1 offset:7168
    v_mfma_f32_16x16x32_bf16 v[76:79], v[100:103], v[164:167], v[76:79]
    s_waitcnt lgkmcnt(5)
    v_mfma_f32_16x16x32_bf16 v[76:79], v[92:95], v[160:163], v[76:79]
    s_cbranch_scc1 L_cloop_n
L_tail_n:
    v_mfma_f32_16x16x32_bf16 v[80:83], v[112:115], v[200:203], v[80:83]
    s_add_u32 s59, s59, 37504
    s_cmp_eq_u32 s59, 112512
    s_cselect_b32 s59, 0, s59
    v_mfma_f32_16x16x32_bf16 v[80:83], v[120:123], v[204:207], v[80:83]
    v_add_u32 v1, s59, v5
    v_add_u32 v2, s59, v11
    v_mfma_f32_16x16x32_bf16 v[80:83], v[128:131], v[208:211], v[80:83]
    v_add_u32 v9, s59, v12
    v_xor_b32 v10, 16, v2
    v_mfma_f32_16x16x32_bf16 v[84:87], v[132:135], v[208:211], v[84:87]
    v_mov_b32 v3, v13
    v_xor_b32 v5, 64, v1
    v_mfma_f32_16x16x32_bf16 v[84:87], v[124:127], v[204:207], v[84:87]
    v_xor_b32 v4, 32, v6
    v_mfma_f32_16x16x32_bf16 v[84:87], v[116:119], v[200:203], v[84:87]
    v_mfma_f32_16x16x32_bf16 v[16:19], v[120:123], v[168:171], v[16:19]
    v_mfma_f32_16x16x32_bf16 v[16:19], v[128:131], v[172:175], v[16:19]
    v_mfma_f32_16x16x32_bf16 v[20:23], v[132:135], v[172:175], v[20:23]
    s_waitcnt lgkmcnt(0)
    v_mfma_f32_16x16x32_bf16 v[20:23], v[124:127], v[168:171], v[20:23]
    s_barrier
    ds_read_b64_tr_b16 v[88:89], v6 offset:25600
    ds_read_b64_tr_b16 v[90:91], v6 offset:26112
    v_mfma_f32_16x16x32_bf16 v[24:27], v[112:115], v[168:171], v[24:27]
    ds_read_b128 v[92:95], v1 offset:0
    v_mfma_f32_16x16x32_bf16 v[24:27], v[120:123], v[172:175], v[24:27]
    ds_read_b64_tr_b16 v[96:97], v6 offset:26624
    ds_read_b64_tr_b16 v[98:99], v6 offset:27136
    v_mfma_f32_16x16x32_bf16 v[24:27], v[128:131], v[176:179], v[24:27]
    ds_read_b128 v[100:103], v1 offset:1024
    v_mfma_f32_16x16x32_bf16 v[28:31], v[132:135], v[176:179], v[28:31]
    ds_read_b64_tr_b16 v[104:105], v4 offset:26624
    ds_read_b64_tr_b16 v[106:107], v4 offset:27136
    v_mfma_f32_16x16x32_bf16 v[28:31], v[124:127], v[172:175], v[28:31]
    ds_read_b64_tr_b16 v[108:109], v4 offset:25600
    ds_read_b64_tr_b16 v[110:111], v4 offset:26112
    v_mfma_f32_16x16x32_bf16 v[28:31], v[116:119], v[168:171], v[28:31]
    ds_read_b64_tr_b16 v[136:137], v6 offset:37888
    ds_read_b64_tr_b16 v[138:139], v6 offset:38400
    v_mfma_f32_16x16x32_bf16 v[32:35], v[112:115], v[172:175], v[32:35]
    ds_read_b128 v[140:143], v5 offset:0
    v_mfma_f32_16x16x32_bf16 v[32:35], v[120:123], v[176:179], v[32:35]
    ds_read_b64_tr_b16 v[144:145], v6 offset:38912
    ds_read_b64_tr_b16 v[146:147], v6 offset:39424
    v_mfma_f32_16x16x32_bf16 v[32:35], v[128:131], v[180:183], v[32:35]
    ds_read_b128 v[148:151], v5 offset:1024
    v_mfma_f32_16x16x32_bf16 v[36:39], v[132:135], v[180:183], v[36:39]
    ds_read_b64_tr_b16 v[152:153], v4 offset:38912
    ds_read_b64_tr_b16 v[154:155], v4 offset:39424
    v_mfma_f32_16x16x32_bf16 v[36:39], v[124:127], v[176:179], v[36:39]
    ds_read_b64_tr_b16 v[156:157], v4 offset:37888
    ds_read_b64_tr_b16 v[158:159], v4 offset:38400
    v_mfma_f32_16x16x32_bf16 v[36:39], v[116:119], v[172:175], v[36:39]
    ds_read_b64_tr_b16 v[160:161], v6 offset:24576
    ds_read_b64_tr_b16 v[162:163], v6 offset:25088
    v_mfma_f32_16x16x32_bf16 v[40:43], v[112:115], v[176:179], v[40:43]
    ds_read_b128 v[164:167], v2 offset:0
    v_mfma_f32_16x16x32_bf16 v[40:43], v[120:123], v[180:183], v[40:43]
    ds_read_b128 v[212:215], v9 offset:0
    v_mfma_f32_16x16x32_bf16 v[40:43], v[128:131], v[184:187], v[40:43]
    ds_read_b128 v[216:219], v10 offset:256
    v_mfma_f32_16x16x32_bf16 v[44:47], v[132:135], v[184:187], v[44:47]
    ds_read_b64_tr_b16 v[220:221], v4 offset:24576
    ds_read_b64_tr_b16 v[222:223], v4 offset:25088
    v_mfma_f32_16x16x32_bf16 v[44:47], v[124:127], v[180:183], v[44:47]
    v_mfma_f32_16x16x32_bf16 v[44:47], v[116:119], v[176:179], v[44:47]
    v_mfma_f32_16x16x32_bf16 v[48:51], v[112:115], v[180:183], v[48:51]
    v_mfma_f32_16x16x32_bf16 v[48:51], v[120:123], v[184:187], v[48:51]
    v_mfma_f32_16x16x32_bf16 v[48:51], v[128:131], v[188:191], v[48:51]
    v_mfma_f32_16x16x32_bf16 v[52:55], v[132:135], v[188:191], v[52:55]
    v_mfma_f32_16x16x32_bf16 v[52:55], v[124:127], v[184:187], v[52:55]
    v_mfma_f32_16x16x32_bf16 v[52:55], v[116:119], v[180:183], v[52:55]
    v_mfma_f32_16x16x32_bf16 v[56:59], v[112:115], v[184:187], v[56:59]
    v_mfma_f32_16x16x32_bf16 v[56:59], v[120:123], v[188:191], v[56:59]
    v_mfma_f32_16x16x32_bf16 v[56:59], v[128:131], v[192:195], v[56:59]
    v_mfma_f32_16x16x32_bf16 v[60:63], v[132:135], v[192:195], v[60:63]
    v_mfma_f32_16x16x32_bf16 v[60:63], v[124:127], v[188:191], v[60:63]
    v_mfma_f32_16x16x32_bf16 v[60:63], v[116:119], v[184:187], v[60:63]
    v_mfma_f32_16x16x32_bf16 v[64:67], v[112:115], v[188:191], v[64:67]
    s_barrier
    ds_read_b64_tr_b16 v[224:225], v6 offset:1024
    ds_read_b64_tr_b16 v[226:227], v6 offset:1536
    v_mfma_f32_16x16x32_bf16 v[64:67], v[120:123], v[192:195], v[64:67]
    ds_read_b128 v[228:231], v1 offset:37504
    v_mfma_f32_16x16x32_bf16 v[64:67], v[128:131], v[196:199], v[64:67]
    ds_read_b64_tr_b16 v[232:233], v6 offset:2048
    ds_read_b64_tr_b16 v[234:235], v6 offset:2560
    v_mfma_f32_16x16x32_bf16 v[68:71], v[132:135], v[196:199], v[68:71]
    ds_read_b128 v[236:239], v1 offset:38528
    v_mfma_f32_16x16x32_bf16 v[68:71], v[124:127], v[192:195], v[68:71]
    ds_read_b64_tr_b16 v[240:241], v4 offset:2048
    ds_read_b64_tr_b16 v[242:243], v4 offset:2560
    v_mfma_f32_16x16x32_bf16 v[68:71], v[116:119], v[188:191], v[68:71]
    ds_read_b64_tr_b16 v[244:245], v4 offset:1024
    ds_read_b64_tr_b16 v[246:247], v4 offset:1536
    v_mfma_f32_16x16x32_bf16 v[72:75], v[112:115], v[192:195], v[72:75]
    ds_read_b128 v[248:251], v5 offset:37504
    v_mfma_f32_16x16x32_bf16 v[72:75], v[120:123], v[196:199], v[72:75]
    ds_read_b128 v[252:255], v5 offset:38528
    v_mfma_f32_16x16x32_bf16 v[76:79], v[124:127], v[196:199], v[76:79]
    ds_read_b64_tr_b16 v[208:209], v6 offset:36864
    ds_read_b64_tr_b16 v[210:211], v6 offset:37376
    v_mfma_f32_16x16x32_bf16 v[76:79], v[116:119], v[192:195], v[76:79]
    s_waitcnt lgkmcnt(8)
    v_xor_b32 v2, 64, v2
    v_xor_b32 v9, 64, v9
    v_mfma_f32_16x16x32_bf16 v[16:19], v[88:91], v[92:95], v[16:19]
    v_xor_b32 v10, 64, v10
    v_mfma_f32_16x16x32_bf16 v[16:19], v[96:99], v[100:103], v[16:19]
    s_barrier
    ds_read_b64_tr_b16 v[204:205], v6 offset:13312
    ds_read_b64_tr_b16 v[206:207], v6 offset:13824
    v_mfma_f32_16x16x32_bf16 v[20:23], v[104:107], v[100:103], v[20:23]
    ds_read_b64_tr_b16 v[200:201], v6 offset:14336
    ds_read_b64_tr_b16 v[202:203], v6 offset:14848
    v_mfma_f32_16x16x32_bf16 v[20:23], v[108:111], v[92:95], v[20:23]
    ds_read_b64_tr_b16 v[168:169], v4 offset:14336
    ds_read_b64_tr_b16 v[170:171], v4 offset:14848
    v_mfma_f32_16x16x32_bf16 v[16:19], v[136:139], v[140:143], v[16:19]
    ds_read_b64_tr_b16 v[172:173], v4 offset:13312
    ds_read_b64_tr_b16 v[174:175], v4 offset:13824
    v_mfma_f32_16x16x32_bf16 v[16:19], v[144:147], v[148:151], v[16:19]
    ds_read_b128 v[176:179], v8 offset:0
    v_mfma_f32_16x16x32_bf16 v[20:23], v[152:155], v[148:151], v[20:23]
    ds_read_b128 v[180:183], v8 offset:64
    v_mfma_f32_16x16x32_bf16 v[20:23], v[156:159], v[140:143], v[20:23]
    ds_read_b128 v[184:187], v8 offset:256
    v_mfma_f32_16x16x32_bf16 v[16:19], v[224:227], v[228:231], v[16:19]
    ds_read_b128 v[128:131], v8 offset:320
    v_mfma_f32_16x16x32_bf16 v[16:19], v[232:235], v[236:239], v[16:19]
    s_waitcnt lgkmcnt(6)
    ds_read_b128 v[132:135], v2 offset:0
    s_branch L_past_n0
L_stub_n:
    s_branch L_back_n
L_past_n0:
    v_mfma_f32_16x16x32_bf16 v[20:23], v[240:243], v[236:239], v[20:23]
    ds_read_b128 v[188:191], v9 offset:0
    v_mfma_f32_16x16x32_bf16 v[20:23], v[244:247], v[228:231], v[20:23]
    ds_read_b128 v[112:115], v10 offset:256
    v_mfma_f32_16x16x32_bf16 v[16:19], v[204:207], v[248:251], v[16:19]
    ds_read_b64_tr_b16 v[120:121], v4 offset:36864
    ds_read_b64_tr_b16 v[122:123], v4 offset:37376
    v_mfma_f32_16x16x32_bf16 v[16:19], v[200:203], v[252:255], v[16:19]
    ds_read_b64_tr_b16 v[124:125], v6 offset:0
    ds_read_b64_tr_b16 v[126:127], v6 offset:512
    v_mfma_f32_16x16x32_bf16 v[20:23], v[168:171], v[252:255], v[20:23]
    s_waitcnt lgkmcnt(7)
    s_mov_b32 s59, 75008
    v_add_u32 v2, s59, v11
    v_mfma_f32_16x16x32_bf16 v[20:23], v[172:175], v[248:251], v[20:23]
    v_add_u32 v9, s59, v12
    v_xor_b32 v10, 16, v2
    v_mfma_f32_16x16x32_bf16 v[80:83], v[160:163], v[164:167], v[80:83]
    ds_read_b128 v[196:199], v2 offset:0
    v_mfma_f32_16x16x32_bf16 v[80:83], v[88:91], v[212:215], v[80:83]
    ds_read_b128 v[116:119], v9 offset:0
    v_mfma_f32_16x16x32_bf16 v[80:83], v[96:99], v[216:219], v[80:83]
    ds_read_b128 v[192:195], v10 offset:256
    v_mfma_f32_16x16x32_bf16 v[84:87], v[104:107], v[216:219], v[84:87]
    ds_read_b64_tr_b16 v[12:13], v4 offset:0
    ds_read_b64_tr_b16 v[14:15], v4 offset:512
    v_pk_fma_f32 v[16:17], v[16:17], v[176:177], v[184:185]
    v_pk_fma_f32 v[18:19], v[18:19], v[178:179], v[186:187]
    v_pk_fma_f32 v[20:21], v[20:21], v[180:181], v[128:129]
    v_pk_fma_f32 v[22:23], v[22:23], v[182:183], v[130:131]
    v_mfma_f32_16x16x32_bf16 v[84:87], v[108:111], v[212:215], v[84:87]
    ds_read_b64_tr_b16 v[216:217], v6 offset:12288
    ds_read_b64_tr_b16 v[218:219], v6 offset:12800
    v_mfma_f32_16x16x32_bf16 v[84:87], v[220:223], v[164:167], v[84:87]
    s_waitcnt lgkmcnt(7)
    v_xor_b32 v2, 64, v2
    v_xor_b32 v9, 64, v9
    v_mfma_f32_16x16x32_bf16 v[80:83], v[208:211], v[132:135], v[80:83]
    v_xor_b32 v10, 64, v10
    v_mfma_f32_16x16x32_bf16 v[80:83], v[136:139], v[188:191], v[80:83]
    v_exp_f32 v212, v16
    v_mfma_f32_16x16x32_bf16 v[80:83], v[144:147], v[112:115], v[80:83]
    v_exp_f32 v213, v17
    v_mfma_f32_16x16x32_bf16 v[84:87], v[152:155], v[112:115], v[84:87]
    ds_read_b128 v[112:115], v2 offset:0
    v_exp_f32 v214, v18
    v_mfma_f32_16x16x32_bf16 v[84:87], v[156:159], v[188:191], v[84:87]
    ds_read_b128 v[188:191], v9 offset:0
    v_fma_f32 v212, v212, s84, s84
    v_mfma_f32_16x16x32_bf16 v[84:87], v[120:123], v[132:135], v[84:87]
    s_waitcnt lgkmcnt(2)
    ds_read_b128 v[132:135], v10 offset:256
    v_exp_f32 v215, v19
    v_mfma_f32_16x16x32_bf16 v[80:83], v[124:127], v[196:199], v[80:83]
    v_exp_f32 v164, v20
    v_mfma_f32_16x16x32_bf16 v[80:83], v[224:227], v[116:119], v[80:83]
    v_exp_f32 v165, v21
    v_mfma_f32_16x16x32_bf16 v[80:83], v[232:235], v[192:195], v[80:83]
    v_exp_f32 v166, v22
    v_fma_f32 v213, v213, s84, s84
    v_mfma_f32_16x16x32_bf16 v[84:87], v[240:243], v[192:195], v[84:87]
    ds_read_b64_tr_b16 v[192:193], v4 offset:12288
    v_fma_f32 v214, v214, s84, s84
    v_mfma_f32_16x16x32_bf16 v[84:87], v[244:247], v[116:119], v[84:87]
    ds_read_b64_tr_b16 v[194:195], v4 offset:12800
    v_exp_f32 v167, v23
    v_mfma_f32_16x16x32_bf16 v[84:87], v[12:15], v[196:199], v[84:87]
    s_waitcnt lgkmcnt(2)
    ds_read_b128 v[116:119], v1 offset:2048
    v_fma_f32 v215, v215, s84, s84
    v_mfma_f32_16x16x32_bf16 v[80:83], v[216:219], v[112:115], v[80:83]
    ds_read_b128 v[196:199], v5 offset:2048
    v_fma_f32 v164, v164, s84, s84
    v_mfma_f32_16x16x32_bf16 v[80:83], v[204:207], v[188:191], v[80:83]
    v_fma_f32 v165, v165, s84, s84
    v_fma_f32 v166, v166, s84, s84
    v_fma_f32 v167, v167, s84, s84
    v_mfma_f32_16x16x32_bf16 v[80:83], v[200:203], v[132:135], v[80:83]
    v_rcp_f32 v212, v212
    v_mfma_f32_16x16x32_bf16 v[84:87], v[168:171], v[132:135], v[84:87]
    ds_read_b128 v[132:135], v1 offset:39552
    v_rcp_f32 v213, v213
    v_mfma_f32_16x16x32_bf16 v[84:87], v[172:175], v[188:191], v[84:87]
    s_waitcnt lgkmcnt(3)
    ds_read_b128 v[188:191], v5 offset:39552
    v_rcp_f32 v214, v214
    v_mfma_f32_16x16x32_bf16 v[84:87], v[192:195], v[112:115], v[84:87]
    ds_read_b128 v[112:115], v1 offset:3072
    v_rcp_f32 v215, v215
    v_mfma_f32_16x16x32_bf16 v[24:27], v[160:163], v[92:95], v[24:27]
    v_rcp_f32 v164, v164
    v_mfma_f32_16x16x32_bf16 v[24:27], v[88:91], v[100:103], v[24:27]
    s_waitcnt lgkmcnt(3)
    v_rcp_f32 v165, v165
    v_mfma_f32_16x16x32_bf16 v[24:27], v[96:99], v[116:119], v[24:27]
    v_rcp_f32 v166, v166
    v_mfma_f32_16x16x32_bf16 v[28:31], v[104:107], v[116:119], v[28:31]
    v_rcp_f32 v167, v167
    v_pk_mul_f32 v[212:213], v[212:213], v[16:17]
    v_pk_mul_f32 v[214:215], v[214:215], v[18:19]
    v_pk_mul_f32 v[164:165], v[164:165], v[20:21]
    v_pk_mul_f32 v[166:167], v[166:167], v[22:23]
    v_pk_fma_f32 v[80:81], v[80:81], v[176:177], v[184:185]
    v_pk_fma_f32 v[82:83], v[82:83], v[178:179], v[186:187]
    v_pk_fma_f32 v[84:85], v[84:85], v[180:181], v[128:129]
    v_pk_fma_f32 v[86:87], v[86:87], v[182:183], v[130:131]
    v_mfma_f32_16x16x32_bf16 v[28:31], v[108:111], v[100:103], v[28:31]
    v_cvt_pk_bf16_f32 v16, v212, v213
    v_cvt_pk_bf16_f32 v17, v214, v215
    v_mfma_f32_16x16x32_bf16 v[28:31], v[220:223], v[92:95], v[28:31]
    ds_read_b128 v[92:95], v5 offset:3072
    v_cvt_pk_bf16_f32 v18, v164, v165
    v_cvt_pk_bf16_f32 v19, v166, v167
    v_mfma_f32_16x16x32_bf16 v[24:27], v[208:211], v[140:143], v[24:27]
    v_permlane16_swap_b32 v16, v18
    v_mfma_f32_16x16x32_bf16 v[24:27], v[136:139], v[148:151], v[24:27]
    v_permlane16_swap_b32 v17, v19
    v_mfma_f32_16x16x32_bf16 v[24:27], v[144:147], v[196:199], v[24:27]
    buffer_store_dwordx4 v[16:19], v7, s[28:31], s86 offen sc1 nt
    v_exp_f32 v212, v80
    v_mfma_f32_16x16x32_bf16 v[28:31], v[152:155], v[196:199], v[28:31]
    ds_read_b128 v[20:23], v1 offset:40576
    v_fma_f32 v212, v212, s84, s84
    v_mfma_f32_16x16x32_bf16 v[28:31], v[156:159], v[148:151], v[28:31]
    ds_read_b128 v[16:19], v5 offset:40576
    v_exp_f32 v213, v81
    v_mfma_f32_16x16x32_bf16 v[28:31], v[120:123], v[140:143], v[28:31]
    ds_read_b128 v[140:143], v1 offset:4096
    v_fma_f32 v213, v213, s84, s84
    v_mfma_f32_16x16x32_bf16 v[24:27], v[124:127], v[228:231], v[24:27]
    v_exp_f32 v214, v82
    v_mfma_f32_16x16x32_bf16 v[24:27], v[224:227], v[236:239], v[24:27]
    s_waitcnt lgkmcnt(3)
    v_exp_f32 v215, v83
    v_mfma_f32_16x16x32_bf16 v[24:27], v[232:235], v[132:135], v[24:27]
    v_exp_f32 v164, v84
    v_mfma_f32_16x16x32_bf16 v[28:31], v[240:243], v[132:135], v[28:31]
    v_exp_f32 v165, v85
    v_fma_f32 v214, v214, s84, s84
    v_mfma_f32_16x16x32_bf16 v[28:31], v[244:247], v[236:239], v[28:31]
    v_exp_f32 v166, v86
    v_mfma_f32_16x16x32_bf16 v[28:31], v[12:15], v[228:231], v[28:31]
    ds_read_b128 v[228:231], v5 offset:4096
    v_exp_f32 v167, v87
    v_mfma_f32_16x16x32_bf16 v[24:27], v[216:219], v[248:251], v[24:27]
    v_fma_f32 v215, v215, s84, s84
    v_fma_f32 v164, v164, s84, s84
    v_mfma_f32_16x16x32_bf16 v[24:27], v[204:207], v[252:255], v[24:27]
    v_fma_f32 v165, v165, s84, s84
    v_fma_f32 v166, v166, s84, s84
    v_mfma_f32_16x16x32_bf16 v[24:27], v[200:203], v[188:191], v[24:27]
    v_fma_f32 v167, v167, s84, s84
    v_rcp_f32 v212, v212
    v_mfma_f32_16x16x32_bf16 v[28:31], v[168:171], v[188:191], v[28:31]
    v_rcp_f32 v213, v213
    v_mfma_f32_16x16x32_bf16 v[28:31], v[172:175], v[252:255], v[28:31]
    v_rcp_f32 v214, v214
    v_mfma_f32_16x16x32_bf16 v[28:31], v[192:195], v[248:251], v[28:31]
    ds_read_b128 v[248:251], v1 offset:41600
    v_rcp_f32 v215, v215
    v_mfma_f32_16x16x32_bf16 v[32:35], v[160:163], v[100:103], v[32:35]
    v_rcp_f32 v164, v164
    v_mfma_f32_16x16x32_bf16 v[32:35], v[88:91], v[116:119], v[32:35]
    v_rcp_f32 v165, v165
    v_mfma_f32_16x16x32_bf16 v[32:35], v[96:99], v[112:115], v[32:35]
    v_rcp_f32 v166, v166
    v_mfma_f32_16x16x32_bf16 v[36:39], v[104:107], v[112:115], v[36:39]
    v_rcp_f32 v167, v167
    v_pk_mul_f32 v[212:213], v[212:213], v[80:81]
    v_pk_mul_f32 v[214:215], v[214:215], v[82:83]
    v_pk_mul_f32 v[164:165], v[164:165], v[84:85]
    v_pk_mul_f32 v[166:167], v[166:167], v[86:87]
    v_pk_fma_f32 v[24:25], v[24:25], v[176:177], v[184:185]
    v_pk_fma_f32 v[26:27], v[26:27], v[178:179], v[186:187]
    v_pk_fma_f32 v[28:29], v[28:29], v[180:181], v[128:129]
    v_pk_fma_f32 v[30:31], v[30:31], v[182:183], v[130:131]
    v_mfma_f32_16x16x32_bf16 v[36:39], v[108:111], v[116:119], v[36:39]
    v_cvt_pk_bf16_f32 v80, v212, v213
    v_cvt_pk_bf16_f32 v81, v214, v215
    v_mfma_f32_16x16x32_bf16 v[36:39], v[220:223], v[100:103], v[36:39]
    ds_read_b128 v[100:103], v5 offset:41600
    v_cvt_pk_bf16_f32 v82, v164, v165
    v_mfma_f32_16x16x32_bf16 v[32:35], v[208:211], v[148:151], v[32:35]
    v_cvt_pk_bf16_f32 v83, v166, v167
    v_permlane16_swap_b32 v80, v82
    v_mfma_f32_16x16x32_bf16 v[32:35], v[136:139], v[196:199], v[32:35]
    v_permlane16_swap_b32 v81, v83
    v_mfma_f32_16x16x32_bf16 v[32:35], v[144:147], v[92:95], v[32:35]
    buffer_store_dwordx4 v[80:83], v3, s[28:31], s94 offen sc1 nt
    v_exp_f32 v212, v24
    v_mfma_f32_16x16x32_bf16 v[36:39], v[152:155], v[92:95], v[36:39]
    ds_read_b128 v[84:87], v1 offset:5120
    v_fma_f32 v212, v212, s84, s84
    v_mfma_f32_16x16x32_bf16 v[36:39], v[156:159], v[196:199], v[36:39]
    v_exp_f32 v213, v25
    v_mfma_f32_16x16x32_bf16 v[36:39], v[120:123], v[148:151], v[36:39]
    v_exp_f32 v214, v26
    v_fma_f32 v213, v213, s84, s84
    v_mfma_f32_16x16x32_bf16 v[32:35], v[124:127], v[236:239], v[32:35]
    v_exp_f32 v215, v27
    v_mfma_f32_16x16x32_bf16 v[32:35], v[224:227], v[132:135], v[32:35]
    s_waitcnt lgkmcnt(1)
    v_exp_f32 v164, v28
    v_fma_f32 v214, v214, s84, s84
    v_mfma_f32_16x16x32_bf16 v[32:35], v[232:235], v[20:23], v[32:35]
    v_exp_f32 v165, v29
    v_mfma_f32_16x16x32_bf16 v[36:39], v[240:243], v[20:23], v[36:39]
    ds_read_b128 v[80:83], v5 offset:5120
    v_fma_f32 v215, v215, s84, s84
    v_mfma_f32_16x16x32_bf16 v[36:39], v[244:247], v[132:135], v[36:39]
    ds_read_b128 v[148:151], v1 offset:42624
    v_exp_f32 v166, v30
    v_mfma_f32_16x16x32_bf16 v[36:39], v[12:15], v[236:239], v[36:39]
    ds_read_b128 v[236:239], v5 offset:42624
    v_fma_f32 v164, v164, s84, s84
    v_mfma_f32_16x16x32_bf16 v[32:35], v[216:219], v[252:255], v[32:35]
    v_exp_f32 v167, v31
    v_fma_f32 v165, v165, s84, s84
    v_mfma_f32_16x16x32_bf16 v[32:35], v[204:207], v[188:191], v[32:35]
    v_fma_f32 v166, v166, s84, s84
    v_fma_f32 v167, v167, s84, s84
    v_mfma_f32_16x16x32_bf16 v[32:35], v[200:203], v[16:19], v[32:35]
    v_rcp_f32 v212, v212
    v_mfma_f32_16x16x32_bf16 v[36:39], v[168:171], v[16:19], v[36:39]
    v_rcp_f32 v213, v213
    v_mfma_f32_16x16x32_bf16 v[36:39], v[172:175], v[188:191], v[36:39]
    v_rcp_f32 v214, v214
    v_mfma_f32_16x16x32_bf16 v[36:39], v[192:195], v[252:255], v[36:39]
    v_rcp_f32 v215, v215
    v_mfma_f32_16x16x32_bf16 v[40:43], v[160:163], v[116:119], v[40:43]
    v_rcp_f32 v164, v164
    v_mfma_f32_16x16x32_bf16 v[40:43], v[88:91], v[112:115], v[40:43]
    v_rcp_f32 v165, v165
    v_mfma_f32_16x16x32_bf16 v[40:43], v[96:99], v[140:143], v[40:43]
    v_rcp_f32 v166, v166
    v_mfma_f32_16x16x32_bf16 v[44:47], v[104:107], v[140:143], v[44:47]
    v_rcp_f32 v167, v167
    v_pk_mul_f32 v[212:213], v[212:213], v[24:25]
    v_pk_mul_f32 v[214:215], v[214:215], v[26:27]
    v_pk_mul_f32 v[164:165], v[164:165], v[28:29]
    v_pk_mul_f32 v[166:167], v[166:167], v[30:31]
    v_pk_fma_f32 v[32:33], v[32:33], v[176:177], v[184:185]
    v_pk_fma_f32 v[34:35], v[34:35], v[178:179], v[186:187]
    v_pk_fma_f32 v[36:37], v[36:37], v[180:181], v[128:129]
    v_pk_fma_f32 v[38:39], v[38:39], v[182:183], v[130:131]
    v_mfma_f32_16x16x32_bf16 v[44:47], v[108:111], v[112:115], v[44:47]
    v_cvt_pk_bf16_f32 v24, v212, v213
    v_cvt_pk_bf16_f32 v25, v214, v215
    v_cvt_pk_bf16_f32 v26, v164, v165
    v_mfma_f32_16x16x32_bf16 v[44:47], v[220:223], v[116:119], v[44:47]
    v_cvt_pk_bf16_f32 v27, v166, v167
    v_mfma_f32_16x16x32_bf16 v[40:43], v[208:211], v[196:199], v[40:43]
    v_permlane16_swap_b32 v24, v26
    v_mfma_f32_16x16x32_bf16 v[40:43], v[136:139], v[92:95], v[40:43]
    v_permlane16_swap_b32 v25, v27
    v_mfma_f32_16x16x32_bf16 v[40:43], v[144:147], v[228:231], v[40:43]
    buffer_store_dwordx4 v[24:27], v7, s[28:31], s87 offen sc1 nt
    v_exp_f32 v212, v32
    v_mfma_f32_16x16x32_bf16 v[44:47], v[152:155], v[228:231], v[44:47]
    ds_read_b128 v[252:255], v1 offset:6144
    v_exp_f32 v213, v33
    v_mfma_f32_16x16x32_bf16 v[44:47], v[156:159], v[92:95], v[44:47]
    v_exp_f32 v214, v34
    v_mfma_f32_16x16x32_bf16 v[44:47], v[120:123], v[196:199], v[44:47]
    v_exp_f32 v215, v35
    v_mfma_f32_16x16x32_bf16 v[40:43], v[124:127], v[132:135], v[40:43]
    v_exp_f32 v164, v36
    v_fma_f32 v212, v212, s84, s84
    v_mfma_f32_16x16x32_bf16 v[40:43], v[224:227], v[20:23], v[40:43]
    v_exp_f32 v165, v37
    v_mfma_f32_16x16x32_bf16 v[40:43], v[232:235], v[248:251], v[40:43]
    v_exp_f32 v166, v38
    v_fma_f32 v213, v213, s84, s84
    v_mfma_f32_16x16x32_bf16 v[44:47], v[240:243], v[248:251], v[44:47]
    ds_read_b128 v[116:119], v5 offset:6144
    v_fma_f32 v214, v214, s84, s84
    v_mfma_f32_16x16x32_bf16 v[44:47], v[244:247], v[20:23], v[44:47]
    ds_read_b128 v[28:31], v1 offset:43648
    v_fma_f32 v215, v215, s84, s84
    v_mfma_f32_16x16x32_bf16 v[44:47], v[12:15], v[132:135], v[44:47]
    ds_read_b128 v[24:27], v5 offset:43648
    v_exp_f32 v167, v39
    v_mfma_f32_16x16x32_bf16 v[40:43], v[216:219], v[188:191], v[40:43]
    v_fma_f32 v164, v164, s84, s84
    v_fma_f32 v165, v165, s84, s84
    v_mfma_f32_16x16x32_bf16 v[40:43], v[204:207], v[16:19], v[40:43]
    v_fma_f32 v166, v166, s84, s84
    v_fma_f32 v167, v167, s84, s84
    v_mfma_f32_16x16x32_bf16 v[40:43], v[200:203], v[100:103], v[40:43]
    v_rcp_f32 v212, v212
    v_mfma_f32_16x16x32_bf16 v[44:47], v[168:171], v[100:103], v[44:47]
    v_rcp_f32 v213, v213
    v_mfma_f32_16x16x32_bf16 v[44:47], v[172:175], v[16:19], v[44:47]
    v_rcp_f32 v214, v214
    v_mfma_f32_16x16x32_bf16 v[44:47], v[192:195], v[188:191], v[44:47]
    v_rcp_f32 v215, v215
    v_mfma_f32_16x16x32_bf16 v[48:51], v[160:163], v[112:115], v[48:51]
    v_rcp_f32 v164, v164
    v_mfma_f32_16x16x32_bf16 v[48:51], v[88:91], v[140:143], v[48:51]
    s_waitcnt lgkmcnt(0)
    v_rcp_f32 v165, v165
    v_mfma_f32_16x16x32_bf16 v[48:51], v[96:99], v[84:87], v[48:51]
    v_rcp_f32 v166, v166
    v_mfma_f32_16x16x32_bf16 v[52:55], v[104:107], v[84:87], v[52:55]
    v_rcp_f32 v167, v167
    v_pk_mul_f32 v[212:213], v[212:213], v[32:33]
    v_pk_mul_f32 v[214:215], v[214:215], v[34:35]
    v_pk_mul_f32 v[164:165], v[164:165], v[36:37]
    v_pk_mul_f32 v[166:167], v[166:167], v[38:39]
    v_pk_fma_f32 v[40:41], v[40:41], v[176:177], v[184:185]
    v_pk_fma_f32 v[42:43], v[42:43], v[178:179], v[186:187]
    v_pk_fma_f32 v[44:45], v[44:45], v[180:181], v[128:129]
    v_pk_fma_f32 v[46:47], v[46:47], v[182:183], v[130:131]
    v_mfma_f32_16x16x32_bf16 v[52:55], v[108:111], v[140:143], v[52:55]
    v_cvt_pk_bf16_f32 v32, v212, v213
    v_cvt_pk_bf16_f32 v33, v214, v215
    v_mfma_f32_16x16x32_bf16 v[52:55], v[220:223], v[112:115], v[52:55]
    v_cvt_pk_bf16_f32 v34, v164, v165
    v_cvt_pk_bf16_f32 v35, v166, v167
    v_mfma_f32_16x16x32_bf16 v[48:51], v[208:211], v[92:95], v[48:51]
    v_permlane16_swap_b32 v32, v34
    v_mfma_f32_16x16x32_bf16 v[48:51], v[136:139], v[228:231], v[48:51]
    v_permlane16_swap_b32 v33, v35
    v_mfma_f32_16x16x32_bf16 v[48:51], v[144:147], v[80:83], v[48:51]
    buffer_store_dwordx4 v[32:35], v7, s[28:31], s88 offen sc1 nt
    v_exp_f32 v212, v40
    v_mfma_f32_16x16x32_bf16 v[52:55], v[152:155], v[80:83], v[52:55]
    ds_read_b128 v[196:199], v1 offset:7168
    v_fma_f32 v212, v212, s84, s84
    v_mfma_f32_16x16x32_bf16 v[52:55], v[156:159], v[228:231], v[52:55]
    v_exp_f32 v213, v41
    v_mfma_f32_16x16x32_bf16 v[52:55], v[120:123], v[92:95], v[52:55]
    v_exp_f32 v214, v42
    v_mfma_f32_16x16x32_bf16 v[48:51], v[124:127], v[20:23], v[48:51]
    ds_read_b128 v[132:135], v5 offset:7168
    v_fma_f32 v213, v213, s84, s84
    v_mfma_f32_16x16x32_bf16 v[48:51], v[224:227], v[248:251], v[48:51]
    ds_read_b128 v[188:191], v1 offset:44672
    v_exp_f32 v215, v43
    v_mfma_f32_16x16x32_bf16 v[48:51], v[232:235], v[148:151], v[48:51]
    ds_read_b128 v[112:115], v5 offset:44672
    v_fma_f32 v214, v214, s84, s84
    v_mfma_f32_16x16x32_bf16 v[52:55], v[240:243], v[148:151], v[52:55]
    v_exp_f32 v164, v44
    v_fma_f32 v215, v215, s84, s84
    v_mfma_f32_16x16x32_bf16 v[52:55], v[244:247], v[248:251], v[52:55]
    v_exp_f32 v165, v45
    v_mfma_f32_16x16x32_bf16 v[52:55], v[12:15], v[20:23], v[52:55]
    v_exp_f32 v166, v46
    v_mfma_f32_16x16x32_bf16 v[48:51], v[216:219], v[16:19], v[48:51]
    v_exp_f32 v167, v47
    v_fma_f32 v164, v164, s84, s84
    v_mfma_f32_16x16x32_bf16 v[48:51], v[204:207], v[100:103], v[48:51]
    v_fma_f32 v165, v165, s84, s84
    v_fma_f32 v166, v166, s84, s84
    v_mfma_f32_16x16x32_bf16 v[48:51], v[200:203], v[236:239], v[48:51]
    v_fma_f32 v167, v167, s84, s84
    v_rcp_f32 v212, v212
    v_mfma_f32_16x16x32_bf16 v[52:55], v[168:171], v[236:239], v[52:55]
    v_rcp_f32 v213, v213
    v_mfma_f32_16x16x32_bf16 v[52:55], v[172:175], v[100:103], v[52:55]
    v_rcp_f32 v214, v214
    v_mfma_f32_16x16x32_bf16 v[52:55], v[192:195], v[16:19], v[52:55]
    v_rcp_f32 v215, v215
    v_mfma_f32_16x16x32_bf16 v[56:59], v[160:163], v[140:143], v[56:59]
    v_rcp_f32 v164, v164
    v_mfma_f32_16x16x32_bf16 v[56:59], v[88:91], v[84:87], v[56:59]
    v_rcp_f32 v165, v165
    v_mfma_f32_16x16x32_bf16 v[56:59], v[96:99], v[252:255], v[56:59]
    v_rcp_f32 v166, v166
    v_mfma_f32_16x16x32_bf16 v[60:63], v[104:107], v[252:255], v[60:63]
    v_rcp_f32 v167, v167
    v_pk_mul_f32 v[212:213], v[212:213], v[40:41]
    v_pk_mul_f32 v[214:215], v[214:215], v[42:43]
    v_pk_mul_f32 v[164:165], v[164:165], v[44:45]
    v_pk_mul_f32 v[166:167], v[166:167], v[46:47]
    v_pk_fma_f32 v[48:49], v[48:49], v[176:177], v[184:185]
    v_pk_fma_f32 v[50:51], v[50:51], v[178:179], v[186:187]
    v_pk_fma_f32 v[52:53], v[52:53], v[180:181], v[128:129]
    v_pk_fma_f32 v[54:55], v[54:55], v[182:183], v[130:131]
    v_mfma_f32_16x16x32_bf16 v[60:63], v[108:111], v[84:87], v[60:63]
    v_cvt_pk_bf16_f32 v40, v212, v213
    v_cvt_pk_bf16_f32 v41, v214, v215
    v_cvt_pk_bf16_f32 v42, v164, v165
    v_mfma_f32_16x16x32_bf16 v[60:63], v[220:223], v[140:143], v[60:63]
    v_cvt_pk_bf16_f32 v43, v166, v167
    v_mfma_f32_16x16x32_bf16 v[56:59], v[208:211], v[228:231], v[56:59]
    v_permlane16_swap_b32 v40, v42
    v_mfma_f32_16x16x32_bf16 v[56:59], v[136:139], v[80:83], v[56:59]
    v_permlane16_swap_b32 v41, v43
    v_mfma_f32_16x16x32_bf16 v[56:59], v[144:147], v[116:119], v[56:59]
    buffer_store_dwordx4 v[40:43], v7, s[28:31], s89 offen sc1 nt
    v_exp_f32 v212, v48
    v_mfma_f32_16x16x32_bf16 v[60:63], v[152:155], v[116:119], v[60:63]
    v_exp_f32 v213, v49
    v_fma_f32 v212, v212, s84, s84
    v_mfma_f32_16x16x32_bf16 v[60:63], v[156:159], v[80:83], v[60:63]
    v_exp_f32 v214, v50
    v_mfma_f32_16x16x32_bf16 v[60:63], v[120:123], v[228:231], v[60:63]
    v_exp_f32 v215, v51
    v_fma_f32 v213, v213, s84, s84
    v_mfma_f32_16x16x32_bf16 v[56:59], v[124:127], v[248:251], v[56:59]
    v_exp_f32 v164, v52
    v_mfma_f32_16x16x32_bf16 v[56:59], v[224:227], v[148:151], v[56:59]
    v_exp_f32 v165, v53
    v_mfma_f32_16x16x32_bf16 v[56:59], v[232:235], v[28:31], v[56:59]
    v_exp_f32 v166, v54
    v_fma_f32 v214, v214, s84, s84
    v_mfma_f32_16x16x32_bf16 v[60:63], v[240:243], v[28:31], v[60:63]
    v_exp_f32 v167, v55
    v_mfma_f32_16x16x32_bf16 v[60:63], v[244:247], v[148:151], v[60:63]
    v_fma_f32 v215, v215, s84, s84
    v_fma_f32 v164, v164, s84, s84
    v_fma_f32 v165, v165, s84, s84
    v_mfma_f32_16x16x32_bf16 v[60:63], v[12:15], v[248:251], v[60:63]
    v_fma_f32 v166, v166, s84, s84
    v_fma_f32 v167, v167, s84, s84
    v_mfma_f32_16x16x32_bf16 v[56:59], v[216:219], v[100:103], v[56:59]
    v_rcp_f32 v212, v212
    v_mfma_f32_16x16x32_bf16 v[56:59], v[204:207], v[236:239], v[56:59]
    v_rcp_f32 v213, v213
    v_mfma_f32_16x16x32_bf16 v[56:59], v[200:203], v[24:27], v[56:59]
    v_rcp_f32 v214, v214
    v_mfma_f32_16x16x32_bf16 v[60:63], v[168:171], v[24:27], v[60:63]
    v_rcp_f32 v215, v215
    v_mfma_f32_16x16x32_bf16 v[60:63], v[172:175], v[236:239], v[60:63]
    v_rcp_f32 v164, v164
    v_mfma_f32_16x16x32_bf16 v[60:63], v[192:195], v[100:103], v[60:63]
    v_rcp_f32 v165, v165
    v_mfma_f32_16x16x32_bf16 v[72:75], v[160:163], v[252:255], v[72:75]
    s_waitcnt lgkmcnt(0)
    v_rcp_f32 v166, v166
    v_mfma_f32_16x16x32_bf16 v[72:75], v[88:91], v[196:199], v[72:75]
    v_rcp_f32 v167, v167
    v_pk_mul_f32 v[212:213], v[212:213], v[48:49]
    v_pk_mul_f32 v[214:215], v[214:215], v[50:51]
    v_pk_mul_f32 v[164:165], v[164:165], v[52:53]
    v_pk_mul_f32 v[166:167], v[166:167], v[54:55]
    v_mfma_f32_16x16x32_bf16 v[76:79], v[108:111], v[196:199], v[76:79]
    v_cvt_pk_bf16_f32 v48, v212, v213
    v_cvt_pk_bf16_f32 v49, v214, v215
    v_cvt_pk_bf16_f32 v50, v164, v165
    v_mfma_f32_16x16x32_bf16 v[76:79], v[220:223], v[252:255], v[76:79]
    v_cvt_pk_bf16_f32 v51, v166, v167
    v_mfma_f32_16x16x32_bf16 v[72:75], v[208:211], v[116:119], v[72:75]
    v_permlane16_swap_b32 v48, v50
    v_mfma_f32_16x16x32_bf16 v[72:75], v[136:139], v[132:135], v[72:75]
    v_permlane16_swap_b32 v49, v51
    v_mfma_f32_16x16x32_bf16 v[76:79], v[156:159], v[132:135], v[76:79]
    buffer_store_dwordx4 v[48:51], v7, s[28:31], s90 offen sc1 nt
    v_pk_fma_f32 v[56:57], v[56:57], v[176:177], v[184:185]
    v_pk_fma_f32 v[58:59], v[58:59], v[178:179], v[186:187]
    v_pk_fma_f32 v[60:61], v[60:61], v[180:181], v[128:129]
    v_pk_fma_f32 v[62:63], v[62:63], v[182:183], v[130:131]
    v_mfma_f32_16x16x32_bf16 v[76:79], v[120:123], v[116:119], v[76:79]
    v_exp_f32 v212, v56
    v_mfma_f32_16x16x32_bf16 v[72:75], v[124:127], v[28:31], v[72:75]
    v_exp_f32 v213, v57
    v_fma_f32 v212, v212, s84, s84
    v_mfma_f32_16x16x32_bf16 v[72:75], v[224:227], v[188:191], v[72:75]
    v_exp_f32 v214, v58
    v_mfma_f32_16x16x32_bf16 v[76:79], v[244:247], v[188:191], v[76:79]
    v_exp_f32 v215, v59
    v_mfma_f32_16x16x32_bf16 v[76:79], v[12:15], v[28:31], v[76:79]
    v_exp_f32 v164, v60
    v_fma_f32 v213, v213, s84, s84
    v_mfma_f32_16x16x32_bf16 v[72:75], v[216:219], v[24:27], v[72:75]
    v_exp_f32 v165, v61
    v_mfma_f32_16x16x32_bf16 v[72:75], v[204:207], v[112:115], v[72:75]
    v_exp_f32 v166, v62
    v_fma_f32 v214, v214, s84, s84
    v_mfma_f32_16x16x32_bf16 v[76:79], v[172:175], v[112:115], v[76:79]
    v_exp_f32 v167, v63
    v_mfma_f32_16x16x32_bf16 v[76:79], v[192:195], v[24:27], v[76:79]
    v_fma_f32 v215, v215, s84, s84
    v_fma_f32 v164, v164, s84, s84
    v_mfma_f32_16x16x32_bf16 v[64:67], v[160:163], v[84:87], v[64:67]
    v_fma_f32 v165, v165, s84, s84
    v_fma_f32 v166, v166, s84, s84
    v_fma_f32 v167, v167, s84, s84
    v_mfma_f32_16x16x32_bf16 v[64:67], v[88:91], v[252:255], v[64:67]
    v_rcp_f32 v212, v212
    v_mfma_f32_16x16x32_bf16 v[64:67], v[96:99], v[196:199], v[64:67]
    v_rcp_f32 v213, v213
    v_mfma_f32_16x16x32_bf16 v[68:71], v[104:107], v[196:199], v[68:71]
    v_rcp_f32 v214, v214
    v_mfma_f32_16x16x32_bf16 v[68:71], v[108:111], v[252:255], v[68:71]
    v_rcp_f32 v215, v215
    v_mfma_f32_16x16x32_bf16 v[68:71], v[220:223], v[84:87], v[68:71]
    v_rcp_f32 v164, v164
    v_mfma_f32_16x16x32_bf16 v[64:67], v[208:211], v[80:83], v[64:67]
    v_rcp_f32 v165, v165
    v_mfma_f32_16x16x32_bf16 v[64:67], v[136:139], v[116:119], v[64:67]
    v_rcp_f32 v166, v166
    v_mfma_f32_16x16x32_bf16 v[64:67], v[144:147], v[132:135], v[64:67]
    v_rcp_f32 v167, v167
    v_pk_mul_f32 v[212:213], v[212:213], v[56:57]
    v_pk_mul_f32 v[214:215], v[214:215], v[58:59]
    v_pk_mul_f32 v[164:165], v[164:165], v[60:61]
    v_pk_mul_f32 v[166:167], v[166:167], v[62:63]
    v_pk_fma_f32 v[72:73], v[72:73], v[176:177], v[184:185]
    v_pk_fma_f32 v[74:75], v[74:75], v[178:179], v[186:187]
    v_pk_fma_f32 v[76:77], v[76:77], v[180:181], v[128:129]
    v_pk_fma_f32 v[78:79], v[78:79], v[182:183], v[130:131]
    v_mfma_f32_16x16x32_bf16 v[68:71], v[152:155], v[132:135], v[68:71]
    v_cvt_pk_bf16_f32 v56, v212, v213
    v_cvt_pk_bf16_f32 v57, v214, v215
    v_mfma_f32_16x16x32_bf16 v[68:71], v[156:159], v[116:119], v[68:71]
    v_cvt_pk_bf16_f32 v58, v164, v165
    v_cvt_pk_bf16_f32 v59, v166, v167
    v_mfma_f32_16x16x32_bf16 v[68:71], v[120:123], v[80:83], v[68:71]
    v_permlane16_swap_b32 v56, v58
    v_mfma_f32_16x16x32_bf16 v[64:67], v[124:127], v[148:151], v[64:67]
    v_permlane16_swap_b32 v57, v59
    v_mfma_f32_16x16x32_bf16 v[64:67], v[224:227], v[28:31], v[64:67]
    buffer_store_dwordx4 v[56:59], v7, s[28:31], s91 offen sc1 nt
    v_exp_f32 v212, v72
    v_mfma_f32_16x16x32_bf16 v[64:67], v[232:235], v[188:191], v[64:67]
    v_exp_f32 v213, v73
    v_mfma_f32_16x16x32_bf16 v[68:71], v[240:243], v[188:191], v[68:71]
    v_exp_f32 v214, v74
    v_fma_f32 v212, v212, s84, s84
    v_mfma_f32_16x16x32_bf16 v[68:71], v[244:247], v[28:31], v[68:71]
    v_exp_f32 v215, v75
    v_mfma_f32_16x16x32_bf16 v[68:71], v[12:15], v[148:151], v[68:71]
    v_exp_f32 v164, v76
    v_fma_f32 v213, v213, s84, s84
    v_mfma_f32_16x16x32_bf16 v[64:67], v[216:219], v[236:239], v[64:67]
    v_exp_f32 v165, v77
    v_mfma_f32_16x16x32_bf16 v[64:67], v[204:207], v[24:27], v[64:67]
    v_exp_f32 v166, v78
    v_mfma_f32_16x16x32_bf16 v[64:67], v[200:203], v[112:115], v[64:67]
    v_exp_f32 v167, v79
    v_fma_f32 v214, v214, s84, s84
    v_mfma_f32_16x16x32_bf16 v[68:71], v[168:171], v[112:115], v[68:71]
    v_fma_f32 v215, v215, s84, s84
    v_fma_f32 v164, v164, s84, s84
    v_mfma_f32_16x16x32_bf16 v[68:71], v[172:175], v[24:27], v[68:71]
    v_fma_f32 v165, v165, s84, s84
    v_fma_f32 v166, v166, s84, s84
    v_fma_f32 v167, v167, s84, s84
    v_mfma_f32_16x16x32_bf16 v[68:71], v[192:195], v[236:239], v[68:71]
    v_rcp_f32 v212, v212
    v_rcp_f32 v213, v213
    v_rcp_f32 v214, v214
    v_pk_mul_f32 v[212:213], v[212:213], v[72:73]
    v_rcp_f32 v215, v215
    v_cvt_pk_bf16_f32 v72, v212, v213
    v_rcp_f32 v164, v164
    v_pk_mul_f32 v[214:215], v[214:215], v[74:75]
    v_rcp_f32 v165, v165
    v_cvt_pk_bf16_f32 v73, v214, v215
    v_rcp_f32 v166, v166
    v_pk_mul_f32 v[164:165], v[164:165], v[76:77]
    v_rcp_f32 v167, v167
    v_cvt_pk_bf16_f32 v74, v164, v165
    v_pk_mul_f32 v[166:167], v[166:167], v[78:79]
    v_pk_fma_f32 v[64:65], v[64:65], v[176:177], v[184:185]
    v_permlane16_swap_b32 v72, v74
    v_cvt_pk_bf16_f32 v75, v166, v167
    v_exp_f32 v36, v64
    v_pk_fma_f32 v[66:67], v[66:67], v[178:179], v[186:187]
    v_permlane16_swap_b32 v73, v75
    buffer_store_dwordx4 v[72:75], v7, s[28:31], s93 offen sc1 nt
    v_exp_f32 v37, v65
    v_pk_fma_f32 v[68:69], v[68:69], v[180:181], v[128:129]
    v_exp_f32 v38, v66
    v_pk_fma_f32 v[70:71], v[70:71], v[182:183], v[130:131]
    v_exp_f32 v39, v67
    v_pk_fma_f32 v[36:37], v[36:37], s[84:85], s[84:85]
    v_exp_f32 v32, v68
    v_pk_fma_f32 v[38:39], v[38:39], s[84:85], s[84:85]
    v_exp_f32 v33, v69
    v_exp_f32 v34, v70
    v_pk_fma_f32 v[32:33], v[32:33], s[84:85], s[84:85]
    v_exp_f32 v35, v71
    v_rcp_f32 v36, v36
    v_pk_fma_f32 v[34:35], v[34:35], s[84:85], s[84:85]
    v_rcp_f32 v37, v37
    v_rcp_f32 v38, v38
    v_pk_mul_f32 v[36:37], v[36:37], v[64:65]
    v_rcp_f32 v39, v39
    v_cvt_pk_bf16_f32 v64, v36, v37
    v_rcp_f32 v32, v32
    v_pk_mul_f32 v[38:39], v[38:39], v[66:67]
    v_rcp_f32 v33, v33
    v_cvt_pk_bf16_f32 v65, v38, v39
    v_rcp_f32 v34, v34
    v_pk_mul_f32 v[32:33], v[32:33], v[68:69]
    v_rcp_f32 v35, v35
    v_cvt_pk_bf16_f32 v66, v32, v33
    v_pk_mul_f32 v[34:35], v[34:35], v[70:71]
    s_nop 0
    v_permlane16_swap_b32 v64, v66
    v_cvt_pk_bf16_f32 v67, v34, v35
    s_nop 0
    s_nop 0
    v_permlane16_swap_b32 v65, v67
    buffer_store_dwordx4 v[64:67], v7, s[28:31], s92 offen sc1 nt
L_tend_n:
    s_endpgm
L_fin_n:
L_page2:
.fill ((0 - (L_page2 - L_base)) & 4095) / 4, 4, 0xbf810000
L_load_s:
    s_load_dwordx8 s[8:15], s[0:1], 16
    v_lshrrev_b32 v8, 1, v0
    v_bfe_u32 v9, v0, 4, 1
    v_lshlrev_b32 v9, 2, v9
    v_xor_b32 v8, v8, v9
    v_mul_u32_u24 v8, 1152, v8
    v_and_b32 v9, 1, v0
    v_lshl_add_u32 v8, v9, 4, v8
    s_lshl_b32 s3, s39, 5
    s_add_u32 s3, s3, 1024
    s_mul_i32 s85, s42, 663552
    s_lshl_b32 s82, s42, 10
    s_add_u32 s82, s82, 24576
    s_cmp_eq_u32 s42, 3
    s_cselect_b32 s3, 1073741824, s3
    s_cselect_b32 s85, 0, s85
    s_cselect_b32 s82, 161792, s82
    s_cselect_b32 s83, 0, -1
    v_add_u32 v6, s3, v8
    s_add_u32 m0, s81, 27648
    v_add_u32 v5, 36864, v5
    buffer_load_dwordx4 v5, s[24:27], s49 offen lds
    buffer_load_dwordx4 v5, s[24:27], s50 offen offset:1024 lds
    buffer_load_dwordx4 v5, s[24:27], s51 offen offset:2048 lds
    s_add_u32 m0, s81, 39936
    s_nop 0
    buffer_load_dwordx4 v5, s[24:27], s52 offen lds
    buffer_load_dwordx4 v5, s[24:27], s53 offen offset:1024 lds
    buffer_load_dwordx4 v5, s[24:27], s54 offen offset:2048 lds
    s_add_u32 m0, s80, 126976
    v_add_u32 v5, 36864, v5
    buffer_load_dwordx4 v2, s[20:23], s45 offen lds
    buffer_load_dwordx4 v2, s[20:23], s46 offen offset:1024 lds
    s_add_u32 m0, s80, 129024
    s_nop 0
    buffer_load_dwordx4 v2, s[20:23], s47 offen lds
    buffer_load_dwordx4 v2, s[20:23], s48 offen offset:1024 lds
    s_waitcnt vmcnt(10)
    s_barrier
    s_add_u32 m0, s81, 55296
    v_add_u32 v2, 0x80, v2
    buffer_load_dwordx4 v5, s[24:27], s49 offen lds
    buffer_load_dwordx4 v5, s[24:27], s50 offen offset:1024 lds
    buffer_load_dwordx4 v5, s[24:27], s51 offen offset:2048 lds
    s_add_u32 m0, s81, 67584
    s_nop 0
    buffer_load_dwordx4 v5, s[24:27], s52 offen lds
    buffer_load_dwordx4 v5, s[24:27], s53 offen offset:1024 lds
    buffer_load_dwordx4 v5, s[24:27], s54 offen offset:2048 lds
    s_and_b32 s3, s83, 55296
    s_add_u32 m0, s3, s82
    v_add_u32 v5, 36864, v5
    buffer_load_dwordx4 v6, s[24:27], s85 offen lds
    s_waitcnt vmcnt(11)
    s_barrier
    s_add_u32 m0, s81, 82944
    v_add_u32 v6, 36864, v6
    buffer_load_dwordx4 v5, s[24:27], s49 offen lds
    buffer_load_dwordx4 v5, s[24:27], s50 offen offset:1024 lds
    buffer_load_dwordx4 v5, s[24:27], s51 offen offset:2048 lds
    s_add_u32 m0, s81, 95232
    s_nop 0
    buffer_load_dwordx4 v5, s[24:27], s52 offen lds
    buffer_load_dwordx4 v5, s[24:27], s53 offen offset:1024 lds
    buffer_load_dwordx4 v5, s[24:27], s54 offen offset:2048 lds
    s_and_b32 s3, s83, 82944
    s_add_u32 m0, s3, s82
    v_add_u32 v5, 36864, v5
    buffer_load_dwordx4 v6, s[24:27], s85 offen lds
    s_waitcnt vmcnt(7)
    s_barrier
    s_add_u32 m0, s80, 143360
    v_add_u32 v6, 36864, v6
    buffer_load_dwordx4 v2, s[20:23], s45 offen lds
    buffer_load_dwordx4 v2, s[20:23], s46 offen offset:1024 lds
    s_add_u32 m0, s80, 145408
    s_nop 0
    buffer_load_dwordx4 v2, s[20:23], s47 offen lds
    buffer_load_dwordx4 v2, s[20:23], s48 offen offset:1024 lds
    s_add_u32 m0, s81, 0
    v_add_u32 v2, 0x80, v2
    buffer_load_dwordx4 v5, s[24:27], s49 offen lds
    buffer_load_dwordx4 v5, s[24:27], s50 offen offset:1024 lds
    buffer_load_dwordx4 v5, s[24:27], s51 offen offset:2048 lds
    s_add_u32 m0, s81, 12288
    s_nop 0
    buffer_load_dwordx4 v5, s[24:27], s52 offen lds
    buffer_load_dwordx4 v5, s[24:27], s53 offen offset:1024 lds
    buffer_load_dwordx4 v5, s[24:27], s54 offen offset:2048 lds
    s_and_b32 s3, s83, 0
    s_add_u32 m0, s3, s82
    v_add_u32 v5, 36864, v5
    buffer_load_dwordx4 v6, s[24:27], s85 offen lds
    s_waitcnt vmcnt(11)
    s_barrier
    s_add_u32 m0, s81, 27648
    v_add_u32 v6, 36864, v6
    buffer_load_dwordx4 v5, s[24:27], s49 offen lds
    buffer_load_dwordx4 v5, s[24:27], s50 offen offset:1024 lds
    buffer_load_dwordx4 v5, s[24:27], s51 offen offset:2048 lds
    s_add_u32 m0, s81, 39936
    s_nop 0
    buffer_load_dwordx4 v5, s[24:27], s52 offen lds
    buffer_load_dwordx4 v5, s[24:27], s53 offen offset:1024 lds
    buffer_load_dwordx4 v5, s[24:27], s54 offen offset:2048 lds
    s_and_b32 s3, s83, 27648
    s_add_u32 m0, s3, s82
    v_add_u32 v5, 36864, v5
    buffer_load_dwordx4 v6, s[24:27], s85 offen lds
    s_waitcnt vmcnt(7)
    s_barrier
    s_add_u32 m0, s80, 110592
    v_add_u32 v6, 36864, v6
    buffer_load_dwordx4 v2, s[20:23], s45 offen lds
    buffer_load_dwordx4 v2, s[20:23], s46 offen offset:1024 lds
    s_add_u32 m0, s80, 112640
    s_nop 0
    buffer_load_dwordx4 v2, s[20:23], s47 offen lds
    buffer_load_dwordx4 v2, s[20:23], s48 offen offset:1024 lds
    s_add_u32 m0, s81, 55296
    v_add_u32 v2, 0x80, v2
    buffer_load_dwordx4 v5, s[24:27], s49 offen lds
    buffer_load_dwordx4 v5, s[24:27], s50 offen offset:1024 lds
    buffer_load_dwordx4 v5, s[24:27], s51 offen offset:2048 lds
    s_add_u32 m0, s81, 67584
    s_nop 0
    buffer_load_dwordx4 v5, s[24:27], s52 offen lds
    buffer_load_dwordx4 v5, s[24:27], s53 offen offset:1024 lds
    buffer_load_dwordx4 v5, s[24:27], s54 offen offset:2048 lds
    s_and_b32 s3, s83, 55296
    s_add_u32 m0, s3, s82
    v_add_u32 v5, 36864, v5
    buffer_load_dwordx4 v6, s[24:27], s85 offen lds
    s_waitcnt vmcnt(11)
    s_barrier
    s_add_u32 m0, s81, 82944
    v_add_u32 v6, 36864, v6
    buffer_load_dwordx4 v5, s[24:27], s49 offen lds
    buffer_load_dwordx4 v5, s[24:27], s50 offen offset:1024 lds
    buffer_load_dwordx4 v5, s[24:27], s51 offen offset:2048 lds
    s_add_u32 m0, s81, 95232
    s_nop 0
    buffer_load_dwordx4 v5, s[24:27], s52 offen lds
    buffer_load_dwordx4 v5, s[24:27], s53 offen offset:1024 lds
    buffer_load_dwordx4 v5, s[24:27], s54 offen offset:2048 lds
    s_and_b32 s3, s83, 82944
    s_add_u32 m0, s3, s82
    v_add_u32 v5, 36864, v5
    buffer_load_dwordx4 v6, s[24:27], s85 offen lds
    s_waitcnt vmcnt(7)
    s_barrier
    s_add_u32 m0, s80, 126976
    v_add_u32 v6, 36864, v6
    buffer_load_dwordx4 v2, s[20:23], s45 offen lds
    buffer_load_dwordx4 v2, s[20:23], s46 offen offset:1024 lds
    s_add_u32 m0, s80, 129024
    s_nop 0
    buffer_load_dwordx4 v2, s[20:23], s47 offen lds
    buffer_load_dwordx4 v2, s[20:23], s48 offen offset:1024 lds
    s_add_u32 m0, s81, 0
    v_add_u32 v2, 0x80, v2
    buffer_load_dwordx4 v5, s[24:27], s49 offen lds
    buffer_load_dwordx4 v5, s[24:27], s50 offen offset:1024 lds
    buffer_load_dwordx4 v5, s[24:27], s51 offen offset:2048 lds
    s_add_u32 m0, s81, 12288
    s_nop 0
    buffer_load_dwordx4 v5, s[24:27], s52 offen lds
    buffer_load_dwordx4 v5, s[24:27], s53 offen offset:1024 lds
    buffer_load_dwordx4 v5, s[24:27], s54 offen offset:2048 lds
    s_and_b32 s3, s83, 0
    s_add_u32 m0, s3, s82
    v_add_u32 v5, 36864, v5
    buffer_load_dwordx4 v6, s[24:27], s85 offen lds
    s_waitcnt vmcnt(11)
    s_barrier
    s_add_u32 m0, s81, 27648
    v_add_u32 v6, 36864, v6
    buffer_load_dwordx4 v5, s[24:27], s49 offen lds
    buffer_load_dwordx4 v5, s[24:27], s50 offen offset:1024 lds
    buffer_load_dwordx4 v5, s[24:27], s51 offen offset:2048 lds
    s_add_u32 m0, s81, 39936
    s_nop 0
    buffer_load_dwordx4 v5, s[24:27], s52 offen lds
    buffer_load_dwordx4 v5, s[24:27], s53 offen offset:1024 lds
    buffer_load_dwordx4 v5, s[24:27], s54 offen offset:2048 lds
    s_and_b32 s3, s83, 27648
    s_add_u32 m0, s3, s82
    v_add_u32 v5, 36864, v5
    buffer_load_dwordx4 v6, s[24:27], s85 offen lds
    s_waitcnt vmcnt(7)
    s_barrier
    s_add_u32 m0, s80, 143360
    v_add_u32 v6, 36864, v6
    buffer_load_dwordx4 v2, s[20:23], s45 offen lds
    buffer_load_dwordx4 v2, s[20:23], s46 offen offset:1024 lds
    s_add_u32 m0, s80, 145408
    s_nop 0
    buffer_load_dwordx4 v2, s[20:23], s47 offen lds
    buffer_load_dwordx4 v2, s[20:23], s48 offen offset:1024 lds
    s_add_u32 m0, s81, 55296
    v_add_u32 v2, 0x80, v2
    buffer_load_dwordx4 v5, s[24:27], s49 offen lds
    buffer_load_dwordx4 v5, s[24:27], s50 offen offset:1024 lds
    buffer_load_dwordx4 v5, s[24:27], s51 offen offset:2048 lds
    s_add_u32 m0, s81, 67584
    s_nop 0
    buffer_load_dwordx4 v5, s[24:27], s52 offen lds
    buffer_load_dwordx4 v5, s[24:27], s53 offen offset:1024 lds
    buffer_load_dwordx4 v5, s[24:27], s54 offen offset:2048 lds
    s_and_b32 s3, s83, 55296
    s_add_u32 m0, s3, s82
    v_add_u32 v5, 36864, v5
    buffer_load_dwordx4 v6, s[24:27], s85 offen lds
    s_waitcnt vmcnt(11)
    s_barrier
    s_add_u32 m0, s81, 82944
    v_add_u32 v6, 36864, v6
    buffer_load_dwordx4 v5, s[24:27], s49 offen lds
    buffer_load_dwordx4 v5, s[24:27], s50 offen offset:1024 lds
    buffer_load_dwordx4 v5, s[24:27], s51 offen offset:2048 lds
    s_add_u32 m0, s81, 95232
    s_nop 0
    buffer_load_dwordx4 v5, s[24:27], s52 offen lds
    buffer_load_dwordx4 v5, s[24:27], s53 offen offset:1024 lds
    buffer_load_dwordx4 v5, s[24:27], s54 offen offset:2048 lds
    s_and_b32 s3, s83, 82944
    s_add_u32 m0, s3, s82
    v_add_u32 v5, 36864, v5
    buffer_load_dwordx4 v6, s[24:27], s85 offen lds
    s_waitcnt vmcnt(7)
    s_barrier
    s_add_u32 m0, s80, 110592
    v_add_u32 v6, 36864, v6
    buffer_load_dwordx4 v2, s[20:23], s45 offen lds
    buffer_load_dwordx4 v2, s[20:23], s46 offen offset:1024 lds
    s_add_u32 m0, s80, 112640
    s_nop 0
    buffer_load_dwordx4 v2, s[20:23], s47 offen lds
    buffer_load_dwordx4 v2, s[20:23], s48 offen offset:1024 lds
    s_add_u32 m0, s81, 0
    v_add_u32 v2, 0x80, v2
    buffer_load_dwordx4 v5, s[24:27], s49 offen lds
    buffer_load_dwordx4 v5, s[24:27], s50 offen offset:1024 lds
    buffer_load_dwordx4 v5, s[24:27], s51 offen offset:2048 lds
    s_add_u32 m0, s81, 12288
    s_nop 0
    buffer_load_dwordx4 v5, s[24:27], s52 offen lds
    buffer_load_dwordx4 v5, s[24:27], s53 offen offset:1024 lds
    buffer_load_dwordx4 v5, s[24:27], s54 offen offset:2048 lds
    s_and_b32 s3, s83, 0
    s_add_u32 m0, s3, s82
    v_add_u32 v5, 36864, v5
    buffer_load_dwordx4 v6, s[24:27], s85 offen lds
    s_waitcnt vmcnt(11)
    s_barrier
    s_add_u32 m0, s81, 27648
    v_add_u32 v6, 36864, v6
    buffer_load_dwordx4 v5, s[24:27], s49 offen lds
    buffer_load_dwordx4 v5, s[24:27], s50 offen offset:1024 lds
    buffer_load_dwordx4 v5, s[24:27], s51 offen offset:2048 lds
    s_add_u32 m0, s81, 39936
    s_nop 0
    buffer_load_dwordx4 v5, s[24:27], s52 offen lds
    buffer_load_dwordx4 v5, s[24:27], s53 offen offset:1024 lds
    buffer_load_dwordx4 v5, s[24:27], s54 offen offset:2048 lds
    s_and_b32 s3, s83, 27648
    s_add_u32 m0, s3, s82
    v_add_u32 v5, 36864, v5
    buffer_load_dwordx4 v6, s[24:27], s85 offen lds
    s_waitcnt vmcnt(7)
    s_barrier
    s_add_u32 m0, s80, 126976
    v_add_u32 v6, 36864, v6
    buffer_load_dwordx4 v2, s[20:23], s45 offen lds
    buffer_load_dwordx4 v2, s[20:23], s46 offen offset:1024 lds
    s_add_u32 m0, s80, 129024
    s_nop 0
    buffer_load_dwordx4 v2, s[20:23], s47 offen lds
    buffer_load_dwordx4 v2, s[20:23], s48 offen offset:1024 lds
    s_add_u32 m0, s81, 55296
    v_add_u32 v2, 0x80, v2
    buffer_load_dwordx4 v5, s[24:27], s49 offen lds
    buffer_load_dwordx4 v5, s[24:27], s50 offen offset:1024 lds
    buffer_load_dwordx4 v5, s[24:27], s51 offen offset:2048 lds
    s_add_u32 m0, s81, 67584
    s_nop 0
    buffer_load_dwordx4 v5, s[24:27], s52 offen lds
    buffer_load_dwordx4 v5, s[24:27], s53 offen offset:1024 lds
    buffer_load_dwordx4 v5, s[24:27], s54 offen offset:2048 lds
    s_and_b32 s3, s83, 55296
    s_add_u32 m0, s3, s82
    v_add_u32 v5, 36864, v5
    buffer_load_dwordx4 v6, s[24:27], s85 offen lds
    s_waitcnt vmcnt(11)
    s_barrier
    s_add_u32 m0, s81, 82944
    v_add_u32 v6, 36864, v6
    buffer_load_dwordx4 v5, s[24:27], s49 offen lds
    buffer_load_dwordx4 v5, s[24:27], s50 offen offset:1024 lds
    buffer_load_dwordx4 v5, s[24:27], s51 offen offset:2048 lds
    s_add_u32 m0, s81, 95232
    s_nop 0
    buffer_load_dwordx4 v5, s[24:27], s52 offen lds
    buffer_load_dwordx4 v5, s[24:27], s53 offen offset:1024 lds
    buffer_load_dwordx4 v5, s[24:27], s54 offen offset:2048 lds
    s_and_b32 s3, s83, 82944
    s_add_u32 m0, s3, s82
    v_add_u32 v5, 36864, v5
    buffer_load_dwordx4 v6, s[24:27], s85 offen lds
    s_waitcnt vmcnt(7)
    s_barrier
    s_add_u32 m0, s80, 143360
    v_add_u32 v6, 36864, v6
    buffer_load_dwordx4 v2, s[20:23], s45 offen lds
    buffer_load_dwordx4 v2, s[20:23], s46 offen offset:1024 lds
    s_add_u32 m0, s80, 145408
    s_nop 0
    buffer_load_dwordx4 v2, s[20:23], s47 offen lds
    buffer_load_dwordx4 v2, s[20:23], s48 offen offset:1024 lds
    s_add_u32 m0, s81, 0
    s_nop 0
    buffer_load_dwordx4 v5, s[24:27], s49 offen lds
    buffer_load_dwordx4 v5, s[24:27], s50 offen offset:1024 lds
    buffer_load_dwordx4 v5, s[24:27], s51 offen offset:2048 lds
    s_add_u32 m0, s81, 12288
    s_nop 0
    buffer_load_dwordx4 v5, s[24:27], s52 offen lds
    buffer_load_dwordx4 v5, s[24:27], s53 offen offset:1024 lds
    buffer_load_dwordx4 v5, s[24:27], s54 offen offset:2048 lds
    s_and_b32 s3, s83, 0
    s_add_u32 m0, s3, s82
    v_add_u32 v5, 36864, v5
    buffer_load_dwordx4 v6, s[24:27], s85 offen lds
    s_waitcnt vmcnt(11)
    s_barrier
    s_add_u32 m0, s81, 27648
    v_add_u32 v6, 36864, v6
    buffer_load_dwordx4 v5, s[24:27], s49 offen lds
    buffer_load_dwordx4 v5, s[24:27], s50 offen offset:1024 lds
    buffer_load_dwordx4 v5, s[24:27], s51 offen offset:2048 lds
    s_add_u32 m0, s81, 39936
    s_nop 0
    buffer_load_dwordx4 v5, s[24:27], s52 offen lds
    buffer_load_dwordx4 v5, s[24:27], s53 offen offset:1024 lds
    buffer_load_dwordx4 v5, s[24:27], s54 offen offset:2048 lds
    s_and_b32 s3, s83, 27648
    s_add_u32 m0, s3, s82
    s_nop 0
    buffer_load_dwordx4 v6, s[24:27], s85 offen lds
    s_and_b32 s3, s83, 55296
    s_add_u32 m0, s3, s82
    v_add_u32 v6, 36864, v6
    buffer_load_dwordx4 v6, s[24:27], s85 offen lds
    s_lshl_b32 s3, s39, 1
    s_add_u32 s3, s3, s42
    s_cmp_ge_u32 s42, 2
    s_cselect_b32 s3, 8, s3
    s_lshl_b32 s3, s3, 7
    v_lshl_add_u32 v20, v0, 1, s3
    s_waitcnt lgkmcnt(0)
    global_load_ushort v24, v20, s[8:9]
    global_load_ushort v25, v20, s[10:11]
    global_load_ushort v26, v20, s[12:13]
    global_load_ushort v27, v20, s[14:15]
    s_waitcnt vmcnt(12)
    s_barrier
    s_and_b32 s3, s83, 82944
    s_add_u32 m0, s3, s82
    v_add_u32 v6, 36864, v6
    buffer_load_dwordx4 v6, s[24:27], s85 offen lds
    s_waitcnt vmcnt(1)
    v_lshlrev_b32 v25, 16, v25
    v_add_f32 v25, 0x3727c5ac, v25
    v_cvt_pk_bf16_f32 v25, v25, v25
    v_lshlrev_b32 v25, 16, v25
    v_sqrt_f32 v25, v25
    v_lshlrev_b32 v26, 16, v26
    v_cvt_pk_bf16_f32 v25, v25, v25
    v_lshlrev_b32 v25, 16, v25
    v_rcp_f32 v25, v25
    v_lshlrev_b32 v24, 16, v24
    v_cvt_pk_bf16_f32 v25, v25, v25
    v_lshlrev_b32 v25, 16, v25
    v_mul_f32 v25, v25, v26
    v_cvt_pk_bf16_f32 v25, v25, v25
    v_lshlrev_b32 v25, 16, v25
    v_lshlrev_b32 v27, 16, v27
    v_fma_f32 v27, -v24, v25, v27
    v_mul_f32 v25, 0xbfb8aa3b, v25
    v_mul_f32 v27, 0xbfb8aa3b, v27
    s_lshl_b32 s3, s42, 9
    s_add_u32 s3, s3, 159744
    v_lshl_add_u32 v28, v0, 2, s3
    ds_write2st64_b32 v28, v25, v27 offset1:1
    s_waitcnt vmcnt(0)
    s_waitcnt lgkmcnt(0)
    s_barrier
    s_endpgm
L_ldend_s:
L_page3:
.fill ((640 - (L_page3 - L_base)) & 4095) / 4, 4, 0xbf810000
L_cons_s:
    s_lshr_b32 s56, s36, 1
    s_and_b32 s57, s36, 1
    v_mul_u32_u24 v13, 8192, v13
    v_add_u32 v14, v13, v14
    v_add_u32 v5, 110592, v14
    s_lshl_b32 s58, s36, 11
    v_lshrrev_b32 v14, 1, v16
    v_lshl_or_b32 v14, v17, 1, v14
    s_lshl_b32 s3, s57, 1
    v_xor_b32 v14, s3, v14
    v_lshlrev_b32 v14, 5, v14
    v_lshl_add_u32 v14, v16, 7, v14
    v_lshl_add_u32 v14, v18, 3, v14
    v_mul_u32_u24 v15, 3072, v10
    s_mul_i32 s3, s56, 12288
    v_add3_u32 v6, v14, v15, s3
    v_mul_u32_u24 v14, 9216, v11
    v_lshrrev_b32 v15, 1, v10
    v_lshl_add_u32 v19, v15, 4, v14
    v_lshl_add_u32 v7, v17, 5, v19
    s_lshl_b32 s32, s57, 6
    s_lshl_b32 s3, s39, 1
    s_add_u32 s3, s3, s56
    s_lshl_b32 s3, s3, 7
    s_add_u32 s3, s3, s32
    s_add_u32 s86, s3, 9289728
    s_mul_i32 s3, s36, 2304
    s_lshl_b32 s33, s39, 5
    s_add_u32 s3, s3, s33
    s_add_u32 s94, s3, 9290752
    s_add_u32 s87, s86, 1152
    s_add_u32 s88, s86, 2304
    s_add_u32 s89, s86, 3456
    s_add_u32 s90, s86, 4608
    s_add_u32 s91, s86, 5760
    s_add_u32 s92, s86, 6912
    s_add_u32 s93, s86, 8064
    s_mov_b32 s84, 0xbfb8aa3b
    s_mov_b32 s85, 0xbfb8aa3b
    s_lshl_b32 s3, s57, 7
    s_lshl_b32 s33, s56, 9
    s_add_u32 s3, s3, s33
    s_add_u32 s3, s3, 159744
    v_lshlrev_b32 v236, 4, v10
    s_mov_b32 s95, s3
    s_lshl_b32 s96, s39, 6
    s_add_u32 s96, s96, 160768
    v_mul_u32_u24 v15, 1152, v17
    v_add_u32 v237, v15, v19
    v_lshl_add_u32 v14, v10, 3, v16
    v_lshlrev_b32 v15, 2, v17
    v_xor_b32 v14, v14, v15
    v_lshlrev_b32 v14, 5, v14
    v_lshl_add_u32 v14, v18, 3, v14
    v_add_u32 v10, 24576, v14
    v_mov_b32 v19, 161792
    s_sub_u32 s3, s58, 1024
    v_add_u32 v13, s3, v5
    s_add_u32 s3, s58, 2048
    v_add_u32 v14, s3, v5
    s_cmp_eq_u32 s36, 0
    s_cselect_b32 s82, 0, -1
    s_cselect_b64 vcc, -1, 0
    v_cndmask_b32 v13, v13, v19, vcc
    s_cmp_eq_u32 s36, 3
    s_cselect_b32 s83, 0, -1
    s_cselect_b64 vcc, -1, 0
    v_cndmask_b32 v14, v14, v19, vcc
    v_mov_b32 v11, v13
    v_mov_b32 v12, v14
    v_mov_b32 v8, v10
    v_xor_b32 v9, 128, v10
    v_mov_b32 v1, v5
    v_add_u32 v2, s58, v5
    v_mov_b32 v3, v6
    v_xor_b32 v4, 32, v6
    v_mov_b32 v80, 0
    v_mov_b32 v81, 0
    v_mov_b32 v82, 0
    v_mov_b32 v83, 0
    v_mov_b32 v84, 0
    v_mov_b32 v85, 0
    v_mov_b32 v86, 0
    v_mov_b32 v87, 0
    s_mov_b32 s59, 0
    s_mov_b32 s80, 0
    s_mov_b32 s81, 7
    s_mov_b32 s30, 9437184
    s_mov_b32 s31, 0x20000
    s_waitcnt lgkmcnt(0)
    s_cmp_eq_u32 s36, 0
    s_cbranch_scc1 L_stub_s
    s_cmp_eq_u32 s36, 1
    s_cbranch_scc1 L_stub_s1
    s_cmp_eq_u32 s36, 2
    s_cbranch_scc1 L_stub_s2
    s_cmp_eq_u32 s36, 3
    s_cbranch_scc1 L_stub_s3
L_back_s:
    v_xor_b32 v240, 64, v1
    s_barrier
    ds_read_b64_tr_b16 v[96:97], v3 offset:1024
    ds_read_b64_tr_b16 v[98:99], v3 offset:1536
    ds_read_b128 v[136:139], v1 offset:0
    ds_read_b64_tr_b16 v[104:105], v3 offset:2048
    ds_read_b64_tr_b16 v[106:107], v3 offset:2560
    ds_read_b128 v[140:143], v1 offset:1024
    ds_read_b64_tr_b16 v[108:109], v4 offset:2048
    ds_read_b64_tr_b16 v[110:111], v4 offset:2560
    ds_read_b64_tr_b16 v[100:101], v4 offset:1024
    ds_read_b64_tr_b16 v[102:103], v4 offset:1536
    ds_read_b64_tr_b16 v[88:89], v3 offset:0
    ds_read_b64_tr_b16 v[90:91], v3 offset:512
    ds_read_b128 v[144:147], v1 offset:2048
    ds_read_b64_tr_b16 v[92:93], v4 offset:0
    ds_read_b64_tr_b16 v[94:95], v4 offset:512
    s_waitcnt lgkmcnt(12)
    v_mfma_f32_16x16x32_bf16 v[16:19], v[96:99], v[136:139], 0
    s_waitcnt lgkmcnt(9)
    ds_read_b128 v[148:151], v1 offset:3072
    s_mov_b32 s80, 55296
    v_mfma_f32_16x16x32_bf16 v[16:19], v[104:107], v[140:143], v[16:19]
    s_waitcnt lgkmcnt(8)
    ds_read_b128 v[152:155], v1 offset:4096
    s_mov_b32 s59, 16384
    v_mfma_f32_16x16x32_bf16 v[20:23], v[108:111], v[140:143], 0
    s_waitcnt lgkmcnt(7)
    ds_read_b128 v[156:159], v1 offset:5120
    v_mfma_f32_16x16x32_bf16 v[20:23], v[100:103], v[136:139], v[20:23]
    s_waitcnt lgkmcnt(6)
    ds_read_b128 v[160:163], v1 offset:6144
    v_mfma_f32_16x16x32_bf16 v[24:27], v[88:91], v[136:139], 0
    ds_read_b128 v[164:167], v1 offset:7168
    v_mfma_f32_16x16x32_bf16 v[24:27], v[96:99], v[140:143], v[24:27]
    s_waitcnt lgkmcnt(7)
    ds_read_b128 v[168:171], v240 offset:0
    v_mfma_f32_16x16x32_bf16 v[24:27], v[104:107], v[144:147], v[24:27]
    ds_read_b128 v[172:175], v240 offset:1024
    v_mfma_f32_16x16x32_bf16 v[28:31], v[108:111], v[144:147], 0
    ds_read_b128 v[176:179], v240 offset:2048
    v_mfma_f32_16x16x32_bf16 v[28:31], v[100:103], v[140:143], v[28:31]
    s_waitcnt lgkmcnt(5)
    ds_read_b128 v[180:183], v240 offset:3072
    v_mfma_f32_16x16x32_bf16 v[28:31], v[92:95], v[136:139], v[28:31]
    ds_read_b128 v[184:187], v240 offset:4096
    v_mfma_f32_16x16x32_bf16 v[32:35], v[88:91], v[140:143], 0
    ds_read_b128 v[188:191], v240 offset:5120
    v_mfma_f32_16x16x32_bf16 v[32:35], v[96:99], v[144:147], v[32:35]
    ds_read_b128 v[192:195], v240 offset:6144
    v_mfma_f32_16x16x32_bf16 v[32:35], v[104:107], v[148:151], v[32:35]
    ds_read_b128 v[196:199], v240 offset:7168
    v_mfma_f32_16x16x32_bf16 v[36:39], v[108:111], v[148:151], 0
    v_mfma_f32_16x16x32_bf16 v[36:39], v[100:103], v[144:147], v[36:39]
    v_mfma_f32_16x16x32_bf16 v[36:39], v[92:95], v[140:143], v[36:39]
    v_mfma_f32_16x16x32_bf16 v[40:43], v[88:91], v[144:147], 0
    v_mfma_f32_16x16x32_bf16 v[40:43], v[96:99], v[148:151], v[40:43]
    v_mfma_f32_16x16x32_bf16 v[40:43], v[104:107], v[152:155], v[40:43]
    v_mfma_f32_16x16x32_bf16 v[44:47], v[108:111], v[152:155], 0
    v_mfma_f32_16x16x32_bf16 v[44:47], v[100:103], v[148:151], v[44:47]
    v_mfma_f32_16x16x32_bf16 v[44:47], v[92:95], v[144:147], v[44:47]
    v_mfma_f32_16x16x32_bf16 v[48:51], v[88:91], v[148:151], 0
    v_mfma_f32_16x16x32_bf16 v[48:51], v[96:99], v[152:155], v[48:51]
    s_barrier
    ds_read_b64_tr_b16 v[120:121], v3 offset:28672
    ds_read_b64_tr_b16 v[122:123], v3 offset:29184
    v_mfma_f32_16x16x32_bf16 v[48:51], v[104:107], v[156:159], v[48:51]
    ds_read_b64_tr_b16 v[128:129], v3 offset:29696
    ds_read_b64_tr_b16 v[130:131], v3 offset:30208
    v_mfma_f32_16x16x32_bf16 v[52:55], v[108:111], v[156:159], 0
    ds_read_b64_tr_b16 v[132:133], v4 offset:29696
    ds_read_b64_tr_b16 v[134:135], v4 offset:30208
    v_mfma_f32_16x16x32_bf16 v[52:55], v[100:103], v[152:155], v[52:55]
    ds_read_b64_tr_b16 v[124:125], v4 offset:28672
    ds_read_b64_tr_b16 v[126:127], v4 offset:29184
    v_mfma_f32_16x16x32_bf16 v[52:55], v[92:95], v[148:151], v[52:55]
    ds_read_b64_tr_b16 v[112:113], v3 offset:27648
    ds_read_b64_tr_b16 v[114:115], v3 offset:28160
    v_mfma_f32_16x16x32_bf16 v[56:59], v[88:91], v[152:155], 0
    ds_read_b64_tr_b16 v[116:117], v4 offset:27648
    ds_read_b64_tr_b16 v[118:119], v4 offset:28160
    v_mfma_f32_16x16x32_bf16 v[56:59], v[96:99], v[156:159], v[56:59]
    s_waitcnt lgkmcnt(10)
    v_mfma_f32_16x16x32_bf16 v[56:59], v[104:107], v[160:163], v[56:59]
    v_mfma_f32_16x16x32_bf16 v[60:63], v[108:111], v[160:163], 0
    v_mfma_f32_16x16x32_bf16 v[60:63], v[100:103], v[156:159], v[60:63]
    v_mfma_f32_16x16x32_bf16 v[60:63], v[92:95], v[152:155], v[60:63]
    v_mfma_f32_16x16x32_bf16 v[64:67], v[88:91], v[156:159], 0
    v_mfma_f32_16x16x32_bf16 v[64:67], v[96:99], v[160:163], v[64:67]
    v_mfma_f32_16x16x32_bf16 v[64:67], v[104:107], v[164:167], v[64:67]
    v_mfma_f32_16x16x32_bf16 v[68:71], v[108:111], v[164:167], 0
    v_mfma_f32_16x16x32_bf16 v[68:71], v[100:103], v[160:163], v[68:71]
    v_mfma_f32_16x16x32_bf16 v[68:71], v[92:95], v[156:159], v[68:71]
    v_mfma_f32_16x16x32_bf16 v[72:75], v[88:91], v[160:163], 0
    v_mfma_f32_16x16x32_bf16 v[72:75], v[96:99], v[164:167], v[72:75]
    v_mfma_f32_16x16x32_bf16 v[76:79], v[100:103], v[164:167], 0
    v_mfma_f32_16x16x32_bf16 v[76:79], v[92:95], v[160:163], v[76:79]
    v_mfma_f32_16x16x32_bf16 v[16:19], v[120:123], v[168:171], v[16:19]
    s_waitcnt lgkmcnt(0)
    v_mfma_f32_16x16x32_bf16 v[16:19], v[128:131], v[172:175], v[16:19]
    v_mfma_f32_16x16x32_bf16 v[20:23], v[132:135], v[172:175], v[20:23]
    v_mfma_f32_16x16x32_bf16 v[20:23], v[124:127], v[168:171], v[20:23]
    v_mfma_f32_16x16x32_bf16 v[24:27], v[112:115], v[168:171], v[24:27]
    v_mfma_f32_16x16x32_bf16 v[24:27], v[120:123], v[172:175], v[24:27]
    v_mfma_f32_16x16x32_bf16 v[24:27], v[128:131], v[176:179], v[24:27]
    v_mfma_f32_16x16x32_bf16 v[28:31], v[132:135], v[176:179], v[28:31]
    v_mfma_f32_16x16x32_bf16 v[28:31], v[124:127], v[172:175], v[28:31]
    v_mfma_f32_16x16x32_bf16 v[28:31], v[116:119], v[168:171], v[28:31]
    v_mfma_f32_16x16x32_bf16 v[32:35], v[112:115], v[172:175], v[32:35]
    v_mfma_f32_16x16x32_bf16 v[32:35], v[120:123], v[176:179], v[32:35]
    v_mfma_f32_16x16x32_bf16 v[32:35], v[128:131], v[180:183], v[32:35]
    v_mfma_f32_16x16x32_bf16 v[36:39], v[132:135], v[180:183], v[36:39]
    v_mfma_f32_16x16x32_bf16 v[36:39], v[124:127], v[176:179], v[36:39]
    v_mfma_f32_16x16x32_bf16 v[36:39], v[116:119], v[172:175], v[36:39]
    s_barrier
    ds_read_b64_tr_b16 v[216:217], v8 offset:55296
    ds_read_b64_tr_b16 v[218:219], v9 offset:55296
    v_mfma_f32_16x16x32_bf16 v[40:43], v[112:115], v[176:179], v[40:43]
    ds_read_b128 v[200:203], v11 offset:0
    v_mfma_f32_16x16x32_bf16 v[40:43], v[120:123], v[180:183], v[40:43]
    ds_read_b64_tr_b16 v[220:221], v8 offset:56320
    ds_read_b64_tr_b16 v[222:223], v9 offset:56320
    v_mfma_f32_16x16x32_bf16 v[40:43], v[128:131], v[184:187], v[40:43]
    ds_read_b128 v[204:207], v2 offset:0
    v_mfma_f32_16x16x32_bf16 v[44:47], v[132:135], v[184:187], v[44:47]
    ds_read_b64_tr_b16 v[224:225], v8 offset:57344
    ds_read_b64_tr_b16 v[226:227], v9 offset:57344
    v_mfma_f32_16x16x32_bf16 v[44:47], v[124:127], v[180:183], v[44:47]
    ds_read_b128 v[208:211], v2 offset:1024
    v_mfma_f32_16x16x32_bf16 v[44:47], v[116:119], v[176:179], v[44:47]
    ds_read_b128 v[212:215], v12 offset:0
    v_mfma_f32_16x16x32_bf16 v[48:51], v[112:115], v[180:183], v[48:51]
    ds_read_b64_tr_b16 v[96:97], v3 offset:56320
    ds_read_b64_tr_b16 v[98:99], v3 offset:56832
    v_mfma_f32_16x16x32_bf16 v[48:51], v[120:123], v[184:187], v[48:51]
    ds_read_b128 v[136:139], v1 offset:16384
    v_mfma_f32_16x16x32_bf16 v[48:51], v[128:131], v[188:191], v[48:51]
    ds_read_b64_tr_b16 v[104:105], v3 offset:57344
    ds_read_b64_tr_b16 v[106:107], v3 offset:57856
    v_mfma_f32_16x16x32_bf16 v[52:55], v[132:135], v[188:191], v[52:55]
    ds_read_b128 v[140:143], v1 offset:17408
    v_mfma_f32_16x16x32_bf16 v[52:55], v[124:127], v[184:187], v[52:55]
    ds_read_b64_tr_b16 v[108:109], v4 offset:57344
    ds_read_b64_tr_b16 v[110:111], v4 offset:57856
    v_mfma_f32_16x16x32_bf16 v[52:55], v[116:119], v[180:183], v[52:55]
    ds_read_b64_tr_b16 v[100:101], v4 offset:56320
    ds_read_b64_tr_b16 v[102:103], v4 offset:56832
    v_mfma_f32_16x16x32_bf16 v[56:59], v[112:115], v[184:187], v[56:59]
    ds_read_b64_tr_b16 v[88:89], v3 offset:55296
    ds_read_b64_tr_b16 v[90:91], v3 offset:55808
    v_mfma_f32_16x16x32_bf16 v[56:59], v[120:123], v[188:191], v[56:59]
    ds_read_b128 v[144:147], v1 offset:18432
    v_mfma_f32_16x16x32_bf16 v[56:59], v[128:131], v[192:195], v[56:59]
    ds_read_b64_tr_b16 v[92:93], v4 offset:55296
    ds_read_b64_tr_b16 v[94:95], v4 offset:55808
    v_mfma_f32_16x16x32_bf16 v[60:63], v[132:135], v[192:195], v[60:63]
    ds_read_b128 v[148:151], v1 offset:19456
    v_mfma_f32_16x16x32_bf16 v[60:63], v[124:127], v[188:191], v[60:63]
    ds_read_b128 v[152:155], v1 offset:20480
    v_mfma_f32_16x16x32_bf16 v[60:63], v[116:119], v[184:187], v[60:63]
    ds_read_b128 v[156:159], v1 offset:21504
    v_mfma_f32_16x16x32_bf16 v[64:67], v[112:115], v[188:191], v[64:67]
    ds_read_b128 v[160:163], v1 offset:22528
    v_mfma_f32_16x16x32_bf16 v[64:67], v[120:123], v[192:195], v[64:67]
    ds_read_b128 v[164:167], v1 offset:23552
    v_add_u32 v1, 16384, v1
    v_mfma_f32_16x16x32_bf16 v[64:67], v[128:131], v[196:199], v[64:67]
    v_mfma_f32_16x16x32_bf16 v[68:71], v[132:135], v[196:199], v[68:71]
    v_mfma_f32_16x16x32_bf16 v[68:71], v[124:127], v[192:195], v[68:71]
    v_mfma_f32_16x16x32_bf16 v[68:71], v[116:119], v[188:191], v[68:71]
    v_mfma_f32_16x16x32_bf16 v[72:75], v[112:115], v[192:195], v[72:75]
    v_mfma_f32_16x16x32_bf16 v[72:75], v[120:123], v[196:199], v[72:75]
    v_mfma_f32_16x16x32_bf16 v[76:79], v[124:127], v[196:199], v[76:79]
    s_waitcnt lgkmcnt(5)
    v_mfma_f32_16x16x32_bf16 v[76:79], v[116:119], v[192:195], v[76:79]
    s_branch L_cmid_s
.p2align 6
L_cloop_s:
    v_mfma_f32_16x16x32_bf16 v[80:83], v[216:219], v[200:203], v[80:83]
    s_add_u32 s80, s80, 27648
    s_cmp_eq_u32 s80, 110592
    v_mfma_f32_16x16x32_bf16 v[80:83], v[220:223], v[204:207], v[80:83]
    s_cselect_b32 s80, 0, s80
    v_add_u32 v3, s80, v6
    v_mfma_f32_16x16x32_bf16 v[80:83], v[224:227], v[208:211], v[80:83]
    v_xor_b32 v4, 32, v3
    v_add_u32 v8, s80, v10
    v_mfma_f32_16x16x32_bf16 v[84:87], v[224:227], v[212:215], v[84:87]
    v_xor_b32 v9, 128, v8
    s_add_u32 s3, s59, s58
    v_mfma_f32_16x16x32_bf16 v[84:87], v[220:223], v[208:211], v[84:87]
    v_add_u32 v2, s3, v5
    s_and_b32 s3, s59, s82
    v_mfma_f32_16x16x32_bf16 v[84:87], v[216:219], v[204:207], v[84:87]
    v_add_u32 v11, s3, v13
    s_and_b32 s3, s59, s83
    v_mfma_f32_16x16x32_bf16 v[16:19], v[120:123], v[168:171], v[16:19]
    v_add_u32 v12, s3, v14
    s_add_u32 s59, s59, 16384
    v_mfma_f32_16x16x32_bf16 v[16:19], v[128:131], v[172:175], v[16:19]
    s_cmp_eq_u32 s59, 49152
    s_cselect_b32 s59, 0, s59
    v_mfma_f32_16x16x32_bf16 v[20:23], v[132:135], v[172:175], v[20:23]
    v_add_u32 v1, s59, v5
    v_mfma_f32_16x16x32_bf16 v[20:23], v[124:127], v[168:171], v[20:23]
    v_mfma_f32_16x16x32_bf16 v[24:27], v[112:115], v[168:171], v[24:27]
    v_mfma_f32_16x16x32_bf16 v[24:27], v[120:123], v[172:175], v[24:27]
    s_waitcnt lgkmcnt(0)
    v_mfma_f32_16x16x32_bf16 v[24:27], v[128:131], v[176:179], v[24:27]
    v_mfma_f32_16x16x32_bf16 v[28:31], v[132:135], v[176:179], v[28:31]
    v_mfma_f32_16x16x32_bf16 v[28:31], v[124:127], v[172:175], v[28:31]
    v_mfma_f32_16x16x32_bf16 v[28:31], v[116:119], v[168:171], v[28:31]
    v_mfma_f32_16x16x32_bf16 v[32:35], v[112:115], v[172:175], v[32:35]
    v_mfma_f32_16x16x32_bf16 v[32:35], v[120:123], v[176:179], v[32:35]
    s_barrier
    v_mfma_f32_16x16x32_bf16 v[32:35], v[128:131], v[180:183], v[32:35]
    ds_read_b64_tr_b16 v[88:89], v3 offset:0
    v_mfma_f32_16x16x32_bf16 v[36:39], v[132:135], v[180:183], v[36:39]
    ds_read_b64_tr_b16 v[90:91], v3 offset:512
    v_mfma_f32_16x16x32_bf16 v[36:39], v[124:127], v[176:179], v[36:39]
    ds_read_b128 v[136:139], v1 offset:0
    v_mfma_f32_16x16x32_bf16 v[36:39], v[116:119], v[172:175], v[36:39]
    ds_read_b64_tr_b16 v[96:97], v3 offset:1024
    v_mfma_f32_16x16x32_bf16 v[40:43], v[112:115], v[176:179], v[40:43]
    ds_read_b64_tr_b16 v[98:99], v3 offset:1536
    v_mfma_f32_16x16x32_bf16 v[40:43], v[120:123], v[180:183], v[40:43]
    ds_read_b128 v[140:143], v1 offset:1024
    v_mfma_f32_16x16x32_bf16 v[40:43], v[128:131], v[184:187], v[40:43]
    ds_read_b64_tr_b16 v[104:105], v3 offset:2048
    v_mfma_f32_16x16x32_bf16 v[44:47], v[132:135], v[184:187], v[44:47]
    ds_read_b64_tr_b16 v[106:107], v3 offset:2560
    v_mfma_f32_16x16x32_bf16 v[44:47], v[124:127], v[180:183], v[44:47]
    ds_read_b128 v[144:147], v1 offset:2048
    v_mfma_f32_16x16x32_bf16 v[44:47], v[116:119], v[176:179], v[44:47]
    ds_read_b64_tr_b16 v[92:93], v4 offset:0
    v_mfma_f32_16x16x32_bf16 v[48:51], v[112:115], v[180:183], v[48:51]
    ds_read_b64_tr_b16 v[94:95], v4 offset:512
    v_mfma_f32_16x16x32_bf16 v[48:51], v[120:123], v[184:187], v[48:51]
    ds_read_b128 v[200:203], v11 offset:0
    v_mfma_f32_16x16x32_bf16 v[48:51], v[128:131], v[188:191], v[48:51]
    ds_read_b64_tr_b16 v[100:101], v4 offset:1024
    v_mfma_f32_16x16x32_bf16 v[52:55], v[132:135], v[188:191], v[52:55]
    ds_read_b64_tr_b16 v[102:103], v4 offset:1536
    v_mfma_f32_16x16x32_bf16 v[52:55], v[124:127], v[184:187], v[52:55]
    ds_read_b128 v[204:207], v2 offset:0
    v_mfma_f32_16x16x32_bf16 v[52:55], v[116:119], v[180:183], v[52:55]
    ds_read_b64_tr_b16 v[108:109], v4 offset:2048
    v_mfma_f32_16x16x32_bf16 v[56:59], v[112:115], v[184:187], v[56:59]
    ds_read_b64_tr_b16 v[110:111], v4 offset:2560
    v_mfma_f32_16x16x32_bf16 v[56:59], v[120:123], v[188:191], v[56:59]
    ds_read_b128 v[208:211], v2 offset:1024
    v_mfma_f32_16x16x32_bf16 v[56:59], v[128:131], v[192:195], v[56:59]
    ds_read_b64_tr_b16 v[216:217], v8 offset:0
    v_mfma_f32_16x16x32_bf16 v[60:63], v[132:135], v[192:195], v[60:63]
    ds_read_b64_tr_b16 v[218:219], v9 offset:0
    v_mfma_f32_16x16x32_bf16 v[60:63], v[124:127], v[188:191], v[60:63]
    ds_read_b128 v[212:215], v12 offset:0
    v_mfma_f32_16x16x32_bf16 v[60:63], v[116:119], v[184:187], v[60:63]
    ds_read_b64_tr_b16 v[220:221], v8 offset:1024
    v_mfma_f32_16x16x32_bf16 v[64:67], v[112:115], v[188:191], v[64:67]
    ds_read_b64_tr_b16 v[222:223], v9 offset:1024
    v_mfma_f32_16x16x32_bf16 v[64:67], v[120:123], v[192:195], v[64:67]
    ds_read_b128 v[148:151], v1 offset:3072
    v_mfma_f32_16x16x32_bf16 v[64:67], v[128:131], v[196:199], v[64:67]
    ds_read_b64_tr_b16 v[224:225], v8 offset:2048
    v_mfma_f32_16x16x32_bf16 v[68:71], v[132:135], v[196:199], v[68:71]
    ds_read_b64_tr_b16 v[226:227], v9 offset:2048
    v_mfma_f32_16x16x32_bf16 v[68:71], v[124:127], v[192:195], v[68:71]
    ds_read_b128 v[152:155], v1 offset:4096
    v_mfma_f32_16x16x32_bf16 v[68:71], v[116:119], v[188:191], v[68:71]
    ds_read_b128 v[156:159], v1 offset:5120
    v_mfma_f32_16x16x32_bf16 v[72:75], v[112:115], v[192:195], v[72:75]
    ds_read_b128 v[160:163], v1 offset:6144
    v_mfma_f32_16x16x32_bf16 v[72:75], v[120:123], v[196:199], v[72:75]
    ds_read_b128 v[164:167], v1 offset:7168
    v_mfma_f32_16x16x32_bf16 v[76:79], v[124:127], v[196:199], v[76:79]
    s_waitcnt lgkmcnt(4)
    v_mfma_f32_16x16x32_bf16 v[76:79], v[116:119], v[192:195], v[76:79]
L_cmid_s:
    v_mfma_f32_16x16x32_bf16 v[80:83], v[216:219], v[200:203], v[80:83]
    s_add_u32 s80, s80, 27648
    s_cmp_eq_u32 s80, 110592
    v_mfma_f32_16x16x32_bf16 v[80:83], v[220:223], v[204:207], v[80:83]
    s_cselect_b32 s80, 0, s80
    v_add_u32 v3, s80, v6
    v_mfma_f32_16x16x32_bf16 v[80:83], v[224:227], v[208:211], v[80:83]
    v_xor_b32 v4, 32, v3
    v_add_u32 v8, s80, v10
    v_mfma_f32_16x16x32_bf16 v[84:87], v[224:227], v[212:215], v[84:87]
    v_xor_b32 v9, 128, v8
    v_xor_b32 v1, 64, v1
    v_mfma_f32_16x16x32_bf16 v[84:87], v[220:223], v[208:211], v[84:87]
    v_xor_b32 v2, 64, v2
    v_xor_b32 v11, 64, v11
    v_mfma_f32_16x16x32_bf16 v[84:87], v[216:219], v[204:207], v[84:87]
    v_xor_b32 v12, 64, v12
    s_sub_u32 s81, s81, 1
    v_mfma_f32_16x16x32_bf16 v[16:19], v[96:99], v[136:139], v[16:19]
    s_cmp_lg_u32 s81, 0
    v_mfma_f32_16x16x32_bf16 v[16:19], v[104:107], v[140:143], v[16:19]
    v_mfma_f32_16x16x32_bf16 v[20:23], v[108:111], v[140:143], v[20:23]
    v_mfma_f32_16x16x32_bf16 v[20:23], v[100:103], v[136:139], v[20:23]
    v_mfma_f32_16x16x32_bf16 v[24:27], v[88:91], v[136:139], v[24:27]
    v_mfma_f32_16x16x32_bf16 v[24:27], v[96:99], v[140:143], v[24:27]
    s_waitcnt lgkmcnt(0)
    v_mfma_f32_16x16x32_bf16 v[24:27], v[104:107], v[144:147], v[24:27]
    v_mfma_f32_16x16x32_bf16 v[28:31], v[108:111], v[144:147], v[28:31]
    v_mfma_f32_16x16x32_bf16 v[28:31], v[100:103], v[140:143], v[28:31]
    v_mfma_f32_16x16x32_bf16 v[28:31], v[92:95], v[136:139], v[28:31]
    v_mfma_f32_16x16x32_bf16 v[32:35], v[88:91], v[140:143], v[32:35]
    v_mfma_f32_16x16x32_bf16 v[32:35], v[96:99], v[144:147], v[32:35]
    s_barrier
    v_mfma_f32_16x16x32_bf16 v[32:35], v[104:107], v[148:151], v[32:35]
    ds_read_b64_tr_b16 v[112:113], v3 offset:0
    v_mfma_f32_16x16x32_bf16 v[36:39], v[108:111], v[148:151], v[36:39]
    ds_read_b64_tr_b16 v[114:115], v3 offset:512
    v_mfma_f32_16x16x32_bf16 v[36:39], v[100:103], v[144:147], v[36:39]
    ds_read_b128 v[168:171], v1 offset:0
    v_mfma_f32_16x16x32_bf16 v[36:39], v[92:95], v[140:143], v[36:39]
    ds_read_b64_tr_b16 v[120:121], v3 offset:1024
    v_mfma_f32_16x16x32_bf16 v[40:43], v[88:91], v[144:147], v[40:43]
    ds_read_b64_tr_b16 v[122:123], v3 offset:1536
    v_mfma_f32_16x16x32_bf16 v[40:43], v[96:99], v[148:151], v[40:43]
    ds_read_b128 v[172:175], v1 offset:1024
    v_mfma_f32_16x16x32_bf16 v[40:43], v[104:107], v[152:155], v[40:43]
    ds_read_b64_tr_b16 v[128:129], v3 offset:2048
    v_mfma_f32_16x16x32_bf16 v[44:47], v[108:111], v[152:155], v[44:47]
    ds_read_b64_tr_b16 v[130:131], v3 offset:2560
    v_mfma_f32_16x16x32_bf16 v[44:47], v[100:103], v[148:151], v[44:47]
    ds_read_b128 v[176:179], v1 offset:2048
    v_mfma_f32_16x16x32_bf16 v[44:47], v[92:95], v[144:147], v[44:47]
    ds_read_b64_tr_b16 v[116:117], v4 offset:0
    v_mfma_f32_16x16x32_bf16 v[48:51], v[88:91], v[148:151], v[48:51]
    ds_read_b64_tr_b16 v[118:119], v4 offset:512
    v_mfma_f32_16x16x32_bf16 v[48:51], v[96:99], v[152:155], v[48:51]
    ds_read_b128 v[200:203], v11 offset:0
    v_mfma_f32_16x16x32_bf16 v[48:51], v[104:107], v[156:159], v[48:51]
    ds_read_b64_tr_b16 v[124:125], v4 offset:1024
    v_mfma_f32_16x16x32_bf16 v[52:55], v[108:111], v[156:159], v[52:55]
    ds_read_b64_tr_b16 v[126:127], v4 offset:1536
    v_mfma_f32_16x16x32_bf16 v[52:55], v[100:103], v[152:155], v[52:55]
    ds_read_b128 v[204:207], v2 offset:0
    v_mfma_f32_16x16x32_bf16 v[52:55], v[92:95], v[148:151], v[52:55]
    ds_read_b64_tr_b16 v[132:133], v4 offset:2048
    v_mfma_f32_16x16x32_bf16 v[56:59], v[88:91], v[152:155], v[56:59]
    ds_read_b64_tr_b16 v[134:135], v4 offset:2560
    v_mfma_f32_16x16x32_bf16 v[56:59], v[96:99], v[156:159], v[56:59]
    ds_read_b128 v[208:211], v2 offset:1024
    v_mfma_f32_16x16x32_bf16 v[56:59], v[104:107], v[160:163], v[56:59]
    ds_read_b64_tr_b16 v[216:217], v8 offset:0
    v_mfma_f32_16x16x32_bf16 v[60:63], v[108:111], v[160:163], v[60:63]
    ds_read_b64_tr_b16 v[218:219], v9 offset:0
    v_mfma_f32_16x16x32_bf16 v[60:63], v[100:103], v[156:159], v[60:63]
    ds_read_b128 v[212:215], v12 offset:0
    v_mfma_f32_16x16x32_bf16 v[60:63], v[92:95], v[152:155], v[60:63]
    ds_read_b64_tr_b16 v[220:221], v8 offset:1024
    v_mfma_f32_16x16x32_bf16 v[64:67], v[88:91], v[156:159], v[64:67]
    ds_read_b64_tr_b16 v[222:223], v9 offset:1024
    v_mfma_f32_16x16x32_bf16 v[64:67], v[96:99], v[160:163], v[64:67]
    ds_read_b128 v[180:183], v1 offset:3072
    v_mfma_f32_16x16x32_bf16 v[64:67], v[104:107], v[164:167], v[64:67]
    ds_read_b64_tr_b16 v[224:225], v8 offset:2048
    v_mfma_f32_16x16x32_bf16 v[68:71], v[108:111], v[164:167], v[68:71]
    ds_read_b64_tr_b16 v[226:227], v9 offset:2048
    v_mfma_f32_16x16x32_bf16 v[68:71], v[100:103], v[160:163], v[68:71]
    ds_read_b128 v[184:187], v1 offset:4096
    v_mfma_f32_16x16x32_bf16 v[68:71], v[92:95], v[156:159], v[68:71]
    ds_read_b128 v[188:191], v1 offset:5120
    v_mfma_f32_16x16x32_bf16 v[72:75], v[88:91], v[160:163], v[72:75]
    ds_read_b128 v[192:195], v1 offset:6144
    v_mfma_f32_16x16x32_bf16 v[72:75], v[96:99], v[164:167], v[72:75]
    ds_read_b128 v[196:199], v1 offset:7168
    v_mfma_f32_16x16x32_bf16 v[76:79], v[100:103], v[164:167], v[76:79]
    s_waitcnt lgkmcnt(4)
    v_mfma_f32_16x16x32_bf16 v[76:79], v[92:95], v[160:163], v[76:79]
    s_cbranch_scc1 L_cloop_s
L_tail_s:
    v_mfma_f32_16x16x32_bf16 v[80:83], v[216:219], v[200:203], v[80:83]
    s_add_u32 s80, s80, 27648
    s_cmp_eq_u32 s80, 110592
    s_cselect_b32 s80, 0, s80
    v_mfma_f32_16x16x32_bf16 v[80:83], v[220:223], v[204:207], v[80:83]
    v_add_u32 v3, s80, v6
    v_xor_b32 v4, 32, v3
    v_mfma_f32_16x16x32_bf16 v[80:83], v[224:227], v[208:211], v[80:83]
    v_add_u32 v8, s80, v10
    v_xor_b32 v9, 128, v8
    v_mfma_f32_16x16x32_bf16 v[84:87], v[224:227], v[212:215], v[84:87]
    s_add_u32 s3, s59, s58
    v_add_u32 v2, s3, v5
    s_and_b32 s3, s59, s82
    s_branch L_past_s0
L_stub_s:
    s_branch L_back_s
L_past_s0:
    v_mfma_f32_16x16x32_bf16 v[84:87], v[220:223], v[208:211], v[84:87]
    v_add_u32 v11, s3, v13
    s_and_b32 s3, s59, s83
    v_mfma_f32_16x16x32_bf16 v[84:87], v[216:219], v[204:207], v[84:87]
    v_add_u32 v12, s3, v14
    s_add_u32 s59, s59, 16384
    v_mfma_f32_16x16x32_bf16 v[16:19], v[120:123], v[168:171], v[16:19]
    s_waitcnt lgkmcnt(0)
    s_cmp_eq_u32 s59, 49152
    s_cselect_b32 s59, 0, s59
    v_mfma_f32_16x16x32_bf16 v[16:19], v[128:131], v[172:175], v[16:19]
    s_barrier
    v_add_u32 v1, s59, v5
    v_add_u32 v0, s95, v236
    v_mfma_f32_16x16x32_bf16 v[20:23], v[132:135], v[172:175], v[20:23]
    v_xor_b32 v5, 64, v1
    v_xor_b32 v238, 32, v6
    v_mfma_f32_16x16x32_bf16 v[20:23], v[124:127], v[168:171], v[20:23]
    ds_read_b64_tr_b16 v[88:89], v8 offset:0
    ds_read_b64_tr_b16 v[90:91], v9 offset:0
    v_mfma_f32_16x16x32_bf16 v[24:27], v[112:115], v[168:171], v[24:27]
    ds_read_b128 v[92:95], v11 offset:0
    v_mfma_f32_16x16x32_bf16 v[24:27], v[120:123], v[172:175], v[24:27]
    ds_read_b64_tr_b16 v[96:97], v8 offset:1024
    ds_read_b64_tr_b16 v[98:99], v9 offset:1024
    v_mfma_f32_16x16x32_bf16 v[24:27], v[128:131], v[176:179], v[24:27]
    ds_read_b128 v[100:103], v2 offset:0
    v_mfma_f32_16x16x32_bf16 v[28:31], v[132:135], v[176:179], v[28:31]
    ds_read_b64_tr_b16 v[104:105], v8 offset:2048
    ds_read_b64_tr_b16 v[106:107], v9 offset:2048
    v_mfma_f32_16x16x32_bf16 v[28:31], v[124:127], v[172:175], v[28:31]
    ds_read_b128 v[108:111], v2 offset:1024
    v_mfma_f32_16x16x32_bf16 v[28:31], v[116:119], v[168:171], v[28:31]
    ds_read_b128 v[136:139], v12 offset:0
    v_mfma_f32_16x16x32_bf16 v[32:35], v[112:115], v[172:175], v[32:35]
    ds_read_b64_tr_b16 v[140:141], v3 offset:1024
    ds_read_b64_tr_b16 v[142:143], v3 offset:1536
    v_mfma_f32_16x16x32_bf16 v[32:35], v[120:123], v[176:179], v[32:35]
    ds_read_b128 v[144:147], v1 offset:0
    v_mfma_f32_16x16x32_bf16 v[32:35], v[128:131], v[180:183], v[32:35]
    ds_read_b64_tr_b16 v[148:149], v3 offset:2048
    ds_read_b64_tr_b16 v[150:151], v3 offset:2560
    v_mfma_f32_16x16x32_bf16 v[36:39], v[132:135], v[180:183], v[36:39]
    ds_read_b128 v[152:155], v1 offset:1024
    v_mfma_f32_16x16x32_bf16 v[36:39], v[124:127], v[176:179], v[36:39]
    ds_read_b64_tr_b16 v[156:157], v4 offset:2048
    ds_read_b64_tr_b16 v[158:159], v4 offset:2560
    v_mfma_f32_16x16x32_bf16 v[36:39], v[116:119], v[172:175], v[36:39]
    ds_read_b64_tr_b16 v[160:161], v4 offset:1024
    ds_read_b64_tr_b16 v[162:163], v4 offset:1536
    v_mfma_f32_16x16x32_bf16 v[40:43], v[112:115], v[176:179], v[40:43]
    ds_read_b128 v[164:167], v5 offset:0
    v_mfma_f32_16x16x32_bf16 v[40:43], v[120:123], v[180:183], v[40:43]
    ds_read_b128 v[228:231], v5 offset:1024
    v_add_u32 v8, 27648, v10
    v_mfma_f32_16x16x32_bf16 v[40:43], v[128:131], v[184:187], v[40:43]
    v_xor_b32 v9, 128, v8
    v_xor_b32 v2, 64, v2
    v_mfma_f32_16x16x32_bf16 v[44:47], v[132:135], v[184:187], v[44:47]
    v_xor_b32 v11, 64, v11
    v_xor_b32 v12, 64, v12
    v_mfma_f32_16x16x32_bf16 v[44:47], v[124:127], v[180:183], v[44:47]
    ds_read_b128 v[232:235], v11 offset:0
    v_mfma_f32_16x16x32_bf16 v[44:47], v[116:119], v[176:179], v[44:47]
    ds_read_b128 v[240:243], v2 offset:0
    v_mfma_f32_16x16x32_bf16 v[48:51], v[112:115], v[180:183], v[48:51]
    ds_read_b128 v[244:247], v2 offset:1024
    v_mfma_f32_16x16x32_bf16 v[48:51], v[120:123], v[184:187], v[48:51]
    ds_read_b128 v[248:251], v12 offset:0
    v_mfma_f32_16x16x32_bf16 v[48:51], v[128:131], v[188:191], v[48:51]
    ds_read_b64_tr_b16 v[252:253], v3 offset:0
    ds_read_b64_tr_b16 v[254:255], v3 offset:512
    v_mfma_f32_16x16x32_bf16 v[52:55], v[132:135], v[188:191], v[52:55]
    ds_read_b128 v[200:203], v1 offset:2048
    v_mfma_f32_16x16x32_bf16 v[52:55], v[124:127], v[184:187], v[52:55]
    ds_read_b64_tr_b16 v[224:225], v4 offset:0
    ds_read_b64_tr_b16 v[226:227], v4 offset:512
    v_mfma_f32_16x16x32_bf16 v[52:55], v[116:119], v[180:183], v[52:55]
    v_mfma_f32_16x16x32_bf16 v[56:59], v[112:115], v[184:187], v[56:59]
    v_mfma_f32_16x16x32_bf16 v[56:59], v[120:123], v[188:191], v[56:59]
    v_mfma_f32_16x16x32_bf16 v[56:59], v[128:131], v[192:195], v[56:59]
    v_mfma_f32_16x16x32_bf16 v[60:63], v[132:135], v[192:195], v[60:63]
    v_mfma_f32_16x16x32_bf16 v[60:63], v[124:127], v[188:191], v[60:63]
    v_mfma_f32_16x16x32_bf16 v[60:63], v[116:119], v[184:187], v[60:63]
    v_mfma_f32_16x16x32_bf16 v[64:67], v[112:115], v[188:191], v[64:67]
    v_mfma_f32_16x16x32_bf16 v[64:67], v[120:123], v[192:195], v[64:67]
    v_mfma_f32_16x16x32_bf16 v[64:67], v[128:131], v[196:199], v[64:67]
    v_mfma_f32_16x16x32_bf16 v[68:71], v[132:135], v[196:199], v[68:71]
    v_mfma_f32_16x16x32_bf16 v[68:71], v[124:127], v[192:195], v[68:71]
    v_mfma_f32_16x16x32_bf16 v[68:71], v[116:119], v[188:191], v[68:71]
    s_barrier
    ds_read_b64_tr_b16 v[212:213], v3 offset:28672
    ds_read_b64_tr_b16 v[214:215], v3 offset:29184
    v_mfma_f32_16x16x32_bf16 v[72:75], v[112:115], v[192:195], v[72:75]
    ds_read_b64_tr_b16 v[220:221], v3 offset:29696
    ds_read_b64_tr_b16 v[222:223], v3 offset:30208
    v_mfma_f32_16x16x32_bf16 v[72:75], v[120:123], v[196:199], v[72:75]
    ds_read_b64_tr_b16 v[208:209], v4 offset:29696
    ds_read_b64_tr_b16 v[210:211], v4 offset:30208
    v_mfma_f32_16x16x32_bf16 v[76:79], v[124:127], v[196:199], v[76:79]
    ds_read_b64_tr_b16 v[216:217], v4 offset:28672
    ds_read_b64_tr_b16 v[218:219], v4 offset:29184
    v_mfma_f32_16x16x32_bf16 v[76:79], v[116:119], v[192:195], v[76:79]
    s_waitcnt lgkmcnt(8)
    ds_read_b64_tr_b16 v[204:205], v8 offset:0
    ds_read_b64_tr_b16 v[206:207], v9 offset:0
    v_mfma_f32_16x16x32_bf16 v[80:83], v[88:91], v[92:95], v[80:83]
    ds_read_b64_tr_b16 v[168:169], v8 offset:1024
    ds_read_b64_tr_b16 v[170:171], v9 offset:1024
    v_mfma_f32_16x16x32_bf16 v[80:83], v[96:99], v[100:103], v[80:83]
    ds_read_b64_tr_b16 v[172:173], v8 offset:2048
    ds_read_b64_tr_b16 v[174:175], v9 offset:2048
    v_mfma_f32_16x16x32_bf16 v[80:83], v[104:107], v[108:111], v[80:83]
    ds_read_b128 v[176:179], v0 offset:0
    v_mfma_f32_16x16x32_bf16 v[84:87], v[104:107], v[136:139], v[84:87]
    ds_read_b128 v[180:183], v0 offset:64
    v_mfma_f32_16x16x32_bf16 v[84:87], v[96:99], v[108:111], v[84:87]
    ds_read_b128 v[184:187], v0 offset:256
    v_mfma_f32_16x16x32_bf16 v[84:87], v[88:91], v[100:103], v[84:87]
    ds_read_b128 v[128:131], v0 offset:320
    v_mfma_f32_16x16x32_bf16 v[16:19], v[140:143], v[144:147], v[16:19]
    ds_read_b64_tr_b16 v[132:133], v3 offset:27648
    ds_read_b64_tr_b16 v[134:135], v3 offset:28160
    v_mfma_f32_16x16x32_bf16 v[16:19], v[148:151], v[152:155], v[16:19]
    ds_read_b128 v[188:191], v5 offset:2048
    v_mfma_f32_16x16x32_bf16 v[20:23], v[156:159], v[152:155], v[20:23]
    ds_read_b64_tr_b16 v[112:113], v4 offset:27648
    ds_read_b64_tr_b16 v[114:115], v4 offset:28160
    v_mfma_f32_16x16x32_bf16 v[20:23], v[160:163], v[144:147], v[20:23]
    s_waitcnt lgkmcnt(7)
    ds_read_b128 v[120:123], v1 offset:3072
    v_mfma_f32_16x16x32_bf16 v[16:19], v[212:215], v[164:167], v[16:19]
    ds_read_b128 v[124:127], v5 offset:3072
    v_mfma_f32_16x16x32_bf16 v[16:19], v[220:223], v[228:231], v[16:19]
    ds_read_b128 v[196:199], v1 offset:4096
    v_mfma_f32_16x16x32_bf16 v[20:23], v[208:211], v[228:231], v[20:23]
    ds_read_b128 v[116:119], v5 offset:4096
    v_add_u32 v8, 55296, v10
    v_mfma_f32_16x16x32_bf16 v[20:23], v[216:219], v[164:167], v[20:23]
    v_xor_b32 v9, 128, v8
    v_add_u32 v2, s58, v1
    v_mfma_f32_16x16x32_bf16 v[80:83], v[204:207], v[232:235], v[80:83]
    s_and_b32 s3, s59, s82
    v_add_u32 v11, s3, v13
    s_and_b32 s3, s59, s83
    v_mfma_f32_16x16x32_bf16 v[80:83], v[168:171], v[240:243], v[80:83]
    v_add_u32 v12, s3, v14
    v_mfma_f32_16x16x32_bf16 v[80:83], v[172:175], v[244:247], v[80:83]
    s_waitcnt lgkmcnt(2)
    ds_read_b64_tr_b16 v[192:193], v8 offset:0
    ds_read_b64_tr_b16 v[194:195], v9 offset:0
    v_pk_fma_f32 v[16:17], v[16:17], v[176:177], v[184:185]
    v_pk_fma_f32 v[18:19], v[18:19], v[178:179], v[186:187]
    v_pk_fma_f32 v[20:21], v[20:21], v[180:181], v[128:129]
    v_pk_fma_f32 v[22:23], v[22:23], v[182:183], v[130:131]
    v_mfma_f32_16x16x32_bf16 v[84:87], v[172:175], v[248:251], v[84:87]
    ds_read_b128 v[92:95], v11 offset:0
    v_mfma_f32_16x16x32_bf16 v[84:87], v[168:171], v[244:247], v[84:87]
    ds_read_b64_tr_b16 v[104:105], v8 offset:1024
    ds_read_b64_tr_b16 v[106:107], v9 offset:1024
    v_mfma_f32_16x16x32_bf16 v[84:87], v[204:207], v[240:243], v[84:87]
    ds_read_b128 v[136:139], v2 offset:0
    v_mfma_f32_16x16x32_bf16 v[24:27], v[252:255], v[144:147], v[24:27]
    ds_read_b64_tr_b16 v[96:97], v8 offset:2048
    ds_read_b64_tr_b16 v[98:99], v9 offset:2048
    v_mfma_f32_16x16x32_bf16 v[24:27], v[140:143], v[152:155], v[24:27]
    ds_read_b128 v[100:103], v2 offset:1024
    v_exp_f32 v108, v16
    v_mfma_f32_16x16x32_bf16 v[24:27], v[148:151], v[200:203], v[24:27]
    ds_read_b128 v[232:235], v12 offset:0
    v_exp_f32 v109, v17
    v_mfma_f32_16x16x32_bf16 v[28:31], v[156:159], v[200:203], v[28:31]
    v_add_u32 v8, 82944, v10
    v_xor_b32 v9, 128, v8
    v_mfma_f32_16x16x32_bf16 v[28:31], v[160:163], v[152:155], v[28:31]
    v_xor_b32 v2, 64, v2
    v_xor_b32 v11, 64, v11
    v_xor_b32 v12, 64, v12
    v_mfma_f32_16x16x32_bf16 v[28:31], v[224:227], v[144:147], v[28:31]
    ds_read_b64_tr_b16 v[248:249], v8 offset:0
    v_exp_f32 v110, v18
    v_mfma_f32_16x16x32_bf16 v[24:27], v[132:135], v[164:167], v[24:27]
    ds_read_b64_tr_b16 v[250:251], v9 offset:0
    v_exp_f32 v111, v19
    v_mfma_f32_16x16x32_bf16 v[24:27], v[212:215], v[228:231], v[24:27]
    ds_read_b128 v[172:175], v11 offset:0
    v_exp_f32 v88, v20
    v_mfma_f32_16x16x32_bf16 v[24:27], v[220:223], v[188:191], v[24:27]
    ds_read_b64_tr_b16 v[244:245], v8 offset:1024
    v_exp_f32 v89, v21
    v_mfma_f32_16x16x32_bf16 v[28:31], v[208:211], v[188:191], v[28:31]
    ds_read_b64_tr_b16 v[246:247], v9 offset:1024
    v_exp_f32 v90, v22
    v_mfma_f32_16x16x32_bf16 v[28:31], v[216:219], v[228:231], v[28:31]
    ds_read_b128 v[168:171], v2 offset:0
    v_exp_f32 v91, v23
    v_pk_fma_f32 v[108:109], v[108:109], s[84:85], s[84:85]
    v_pk_fma_f32 v[110:111], v[110:111], s[84:85], s[84:85]
    v_pk_fma_f32 v[88:89], v[88:89], s[84:85], s[84:85]
    v_pk_fma_f32 v[90:91], v[90:91], s[84:85], s[84:85]
    v_mfma_f32_16x16x32_bf16 v[28:31], v[112:115], v[164:167], v[28:31]
    ds_read_b64_tr_b16 v[240:241], v8 offset:2048
    v_rcp_f32 v108, v108
    v_mfma_f32_16x16x32_bf16 v[32:35], v[252:255], v[152:155], v[32:35]
    ds_read_b64_tr_b16 v[242:243], v9 offset:2048
    v_rcp_f32 v109, v109
    v_mfma_f32_16x16x32_bf16 v[32:35], v[140:143], v[200:203], v[32:35]
    ds_read_b128 v[204:207], v2 offset:1024
    v_rcp_f32 v110, v110
    v_mfma_f32_16x16x32_bf16 v[32:35], v[148:151], v[120:123], v[32:35]
    ds_read_b128 v[144:147], v12 offset:0
    v_rcp_f32 v111, v111
    v_mfma_f32_16x16x32_bf16 v[36:39], v[156:159], v[120:123], v[36:39]
    ds_read_b128 v[164:167], v1 offset:5120
    v_rcp_f32 v88, v88
    v_mfma_f32_16x16x32_bf16 v[36:39], v[160:163], v[200:203], v[36:39]
    v_add_u32 v236, s96, v236
    v_rcp_f32 v89, v89
    v_mfma_f32_16x16x32_bf16 v[36:39], v[224:227], v[152:155], v[36:39]
    ds_read_b128 v[152:155], v236 offset:0
    v_rcp_f32 v90, v90
    v_mfma_f32_16x16x32_bf16 v[32:35], v[132:135], v[228:231], v[32:35]
    v_rcp_f32 v91, v91
    v_pk_mul_f32 v[108:109], v[108:109], v[16:17]
    v_pk_mul_f32 v[110:111], v[110:111], v[18:19]
    v_pk_mul_f32 v[88:89], v[88:89], v[20:21]
    v_pk_mul_f32 v[90:91], v[90:91], v[22:23]
    v_pk_fma_f32 v[24:25], v[24:25], v[176:177], v[184:185]
    v_pk_fma_f32 v[26:27], v[26:27], v[178:179], v[186:187]
    v_pk_fma_f32 v[28:29], v[28:29], v[180:181], v[128:129]
    v_pk_fma_f32 v[30:31], v[30:31], v[182:183], v[130:131]
    v_mfma_f32_16x16x32_bf16 v[32:35], v[212:215], v[188:191], v[32:35]
    v_cvt_pk_bf16_f32 v16, v108, v109
    v_cvt_pk_bf16_f32 v17, v110, v111
    v_mfma_f32_16x16x32_bf16 v[32:35], v[220:223], v[124:127], v[32:35]
    v_cvt_pk_bf16_f32 v18, v88, v89
    v_cvt_pk_bf16_f32 v19, v90, v91
    v_mfma_f32_16x16x32_bf16 v[36:39], v[208:211], v[124:127], v[36:39]
    v_permlane16_swap_b32 v16, v18
    v_mfma_f32_16x16x32_bf16 v[36:39], v[216:219], v[188:191], v[36:39]
    v_permlane16_swap_b32 v17, v19
    v_mfma_f32_16x16x32_bf16 v[36:39], v[112:115], v[228:231], v[36:39]
    buffer_store_dwordx4 v[16:19], v7, s[28:31], s86 offen sc1 nt
    v_exp_f32 v108, v24
    v_mfma_f32_16x16x32_bf16 v[40:43], v[252:255], v[200:203], v[40:43]
    ds_read_b128 v[228:231], v236 offset:256
    v_exp_f32 v109, v25
    v_mfma_f32_16x16x32_bf16 v[40:43], v[140:143], v[120:123], v[40:43]
    s_waitcnt lgkmcnt(1)
    ds_read_b128 v[20:23], v5 offset:5120
    v_exp_f32 v110, v26
    v_mfma_f32_16x16x32_bf16 v[40:43], v[148:151], v[196:199], v[40:43]
    ds_read_b128 v[16:19], v1 offset:6144
    v_exp_f32 v111, v27
    v_mfma_f32_16x16x32_bf16 v[44:47], v[156:159], v[196:199], v[44:47]
    v_exp_f32 v88, v28
    v_mfma_f32_16x16x32_bf16 v[44:47], v[160:163], v[120:123], v[44:47]
    v_exp_f32 v89, v29
    v_mfma_f32_16x16x32_bf16 v[44:47], v[224:227], v[200:203], v[44:47]
    ds_read_b128 v[200:203], v5 offset:6144
    v_exp_f32 v90, v30
    v_mfma_f32_16x16x32_bf16 v[40:43], v[132:135], v[188:191], v[40:43]
    v_exp_f32 v91, v31
    v_pk_fma_f32 v[108:109], v[108:109], s[84:85], s[84:85]
    v_pk_fma_f32 v[110:111], v[110:111], s[84:85], s[84:85]
    v_pk_fma_f32 v[88:89], v[88:89], s[84:85], s[84:85]
    v_pk_fma_f32 v[90:91], v[90:91], s[84:85], s[84:85]
    v_pk_fma_f32 v[32:33], v[32:33], v[176:177], v[184:185]
    v_pk_fma_f32 v[34:35], v[34:35], v[178:179], v[186:187]
    v_pk_fma_f32 v[36:37], v[36:37], v[180:181], v[128:129]
    v_pk_fma_f32 v[38:39], v[38:39], v[182:183], v[130:131]
    s_branch L_past_s1
L_stub_s1:
    s_branch L_back_s
L_past_s1:
    v_mfma_f32_16x16x32_bf16 v[40:43], v[212:215], v[124:127], v[40:43]
    v_rcp_f32 v108, v108
    v_mfma_f32_16x16x32_bf16 v[40:43], v[220:223], v[116:119], v[40:43]
    v_rcp_f32 v109, v109
    v_mfma_f32_16x16x32_bf16 v[44:47], v[208:211], v[116:119], v[44:47]
    v_rcp_f32 v110, v110
    v_mfma_f32_16x16x32_bf16 v[44:47], v[216:219], v[124:127], v[44:47]
    v_rcp_f32 v111, v111
    v_mfma_f32_16x16x32_bf16 v[44:47], v[112:115], v[188:191], v[44:47]
    ds_read_b128 v[188:191], v1 offset:7168
    v_rcp_f32 v88, v88
    v_mfma_f32_16x16x32_bf16 v[80:83], v[192:195], v[92:95], v[80:83]
    ds_read_b128 v[92:95], v5 offset:7168
    v_rcp_f32 v89, v89
    v_mfma_f32_16x16x32_bf16 v[80:83], v[104:107], v[136:139], v[80:83]
    v_rcp_f32 v90, v90
    v_mfma_f32_16x16x32_bf16 v[80:83], v[96:99], v[100:103], v[80:83]
    v_rcp_f32 v91, v91
    v_pk_mul_f32 v[108:109], v[108:109], v[24:25]
    v_pk_mul_f32 v[110:111], v[110:111], v[26:27]
    v_pk_mul_f32 v[88:89], v[88:89], v[28:29]
    v_pk_mul_f32 v[90:91], v[90:91], v[30:31]
    v_mfma_f32_16x16x32_bf16 v[84:87], v[96:99], v[232:235], v[84:87]
    v_cvt_pk_bf16_f32 v24, v108, v109
    v_cvt_pk_bf16_f32 v25, v110, v111
    v_mfma_f32_16x16x32_bf16 v[84:87], v[104:107], v[100:103], v[84:87]
    v_cvt_pk_bf16_f32 v26, v88, v89
    v_cvt_pk_bf16_f32 v27, v90, v91
    v_mfma_f32_16x16x32_bf16 v[84:87], v[192:195], v[136:139], v[84:87]
    v_permlane16_swap_b32 v24, v26
    v_mfma_f32_16x16x32_bf16 v[80:83], v[248:251], v[172:175], v[80:83]
    v_permlane16_swap_b32 v25, v27
    v_mfma_f32_16x16x32_bf16 v[80:83], v[244:247], v[168:171], v[80:83]
    buffer_store_dwordx4 v[24:27], v7, s[28:31], s87 offen sc1 nt
    v_exp_f32 v108, v32
    v_mfma_f32_16x16x32_bf16 v[80:83], v[240:243], v[204:207], v[80:83]
    v_exp_f32 v109, v33
    v_mfma_f32_16x16x32_bf16 v[84:87], v[240:243], v[144:147], v[84:87]
    v_exp_f32 v110, v34
    v_mfma_f32_16x16x32_bf16 v[84:87], v[244:247], v[204:207], v[84:87]
    v_exp_f32 v111, v35
    v_mfma_f32_16x16x32_bf16 v[84:87], v[248:251], v[168:171], v[84:87]
    v_exp_f32 v88, v36
    v_mfma_f32_16x16x32_bf16 v[48:51], v[252:255], v[120:123], v[48:51]
    v_exp_f32 v89, v37
    v_mfma_f32_16x16x32_bf16 v[48:51], v[140:143], v[196:199], v[48:51]
    v_exp_f32 v90, v38
    v_mfma_f32_16x16x32_bf16 v[48:51], v[148:151], v[164:167], v[48:51]
    v_exp_f32 v91, v39
    v_pk_fma_f32 v[108:109], v[108:109], s[84:85], s[84:85]
    v_pk_fma_f32 v[110:111], v[110:111], s[84:85], s[84:85]
    v_pk_fma_f32 v[88:89], v[88:89], s[84:85], s[84:85]
    v_pk_fma_f32 v[90:91], v[90:91], s[84:85], s[84:85]
    v_pk_fma_f32 v[40:41], v[40:41], v[176:177], v[184:185]
    v_pk_fma_f32 v[42:43], v[42:43], v[178:179], v[186:187]
    v_pk_fma_f32 v[44:45], v[44:45], v[180:181], v[128:129]
    v_pk_fma_f32 v[46:47], v[46:47], v[182:183], v[130:131]
    v_mfma_f32_16x16x32_bf16 v[52:55], v[156:159], v[164:167], v[52:55]
    v_rcp_f32 v108, v108
    v_mfma_f32_16x16x32_bf16 v[52:55], v[160:163], v[196:199], v[52:55]
    v_rcp_f32 v109, v109
    v_mfma_f32_16x16x32_bf16 v[52:55], v[224:227], v[120:123], v[52:55]
    v_rcp_f32 v110, v110
    v_mfma_f32_16x16x32_bf16 v[48:51], v[132:135], v[124:127], v[48:51]
    v_rcp_f32 v111, v111
    v_mfma_f32_16x16x32_bf16 v[48:51], v[212:215], v[116:119], v[48:51]
    s_waitcnt lgkmcnt(0)
    v_rcp_f32 v88, v88
    v_mfma_f32_16x16x32_bf16 v[48:51], v[220:223], v[20:23], v[48:51]
    v_rcp_f32 v89, v89
    v_mfma_f32_16x16x32_bf16 v[52:55], v[208:211], v[20:23], v[52:55]
    v_rcp_f32 v90, v90
    v_mfma_f32_16x16x32_bf16 v[52:55], v[216:219], v[116:119], v[52:55]
    v_rcp_f32 v91, v91
    v_pk_mul_f32 v[108:109], v[108:109], v[32:33]
    v_pk_mul_f32 v[110:111], v[110:111], v[34:35]
    v_pk_mul_f32 v[88:89], v[88:89], v[36:37]
    v_pk_mul_f32 v[90:91], v[90:91], v[38:39]
    v_mfma_f32_16x16x32_bf16 v[52:55], v[112:115], v[124:127], v[52:55]
    v_cvt_pk_bf16_f32 v32, v108, v109
    v_cvt_pk_bf16_f32 v33, v110, v111
    v_mfma_f32_16x16x32_bf16 v[56:59], v[252:255], v[196:199], v[56:59]
    v_cvt_pk_bf16_f32 v34, v88, v89
    v_cvt_pk_bf16_f32 v35, v90, v91
    v_mfma_f32_16x16x32_bf16 v[56:59], v[140:143], v[164:167], v[56:59]
    v_permlane16_swap_b32 v32, v34
    v_mfma_f32_16x16x32_bf16 v[56:59], v[148:151], v[16:19], v[56:59]
    v_permlane16_swap_b32 v33, v35
    v_mfma_f32_16x16x32_bf16 v[60:63], v[156:159], v[16:19], v[60:63]
    buffer_store_dwordx4 v[32:35], v7, s[28:31], s88 offen sc1 nt
    v_exp_f32 v108, v40
    v_mfma_f32_16x16x32_bf16 v[60:63], v[160:163], v[164:167], v[60:63]
    v_exp_f32 v109, v41
    v_mfma_f32_16x16x32_bf16 v[60:63], v[224:227], v[196:199], v[60:63]
    v_exp_f32 v110, v42
    v_mfma_f32_16x16x32_bf16 v[56:59], v[132:135], v[116:119], v[56:59]
    v_exp_f32 v111, v43
    v_mfma_f32_16x16x32_bf16 v[56:59], v[212:215], v[20:23], v[56:59]
    v_exp_f32 v88, v44
    v_mfma_f32_16x16x32_bf16 v[56:59], v[220:223], v[200:203], v[56:59]
    v_exp_f32 v89, v45
    v_mfma_f32_16x16x32_bf16 v[60:63], v[208:211], v[200:203], v[60:63]
    v_exp_f32 v90, v46
    v_mfma_f32_16x16x32_bf16 v[60:63], v[216:219], v[20:23], v[60:63]
    v_exp_f32 v91, v47
    v_pk_fma_f32 v[108:109], v[108:109], s[84:85], s[84:85]
    v_pk_fma_f32 v[110:111], v[110:111], s[84:85], s[84:85]
    v_pk_fma_f32 v[88:89], v[88:89], s[84:85], s[84:85]
    v_pk_fma_f32 v[90:91], v[90:91], s[84:85], s[84:85]
    v_pk_fma_f32 v[80:81], v[80:81], v[152:153], v[228:229]
    v_pk_fma_f32 v[82:83], v[82:83], v[154:155], v[230:231]
    v_pk_fma_f32 v[84:85], v[84:85], v[152:153], v[228:229]
    v_pk_fma_f32 v[86:87], v[86:87], v[154:155], v[230:231]
    v_mfma_f32_16x16x32_bf16 v[60:63], v[112:115], v[116:119], v[60:63]
    v_rcp_f32 v108, v108
    v_mfma_f32_16x16x32_bf16 v[72:75], v[252:255], v[16:19], v[72:75]
    v_rcp_f32 v109, v109
    v_mfma_f32_16x16x32_bf16 v[72:75], v[140:143], v[188:191], v[72:75]
    v_rcp_f32 v110, v110
    v_mfma_f32_16x16x32_bf16 v[76:79], v[160:163], v[188:191], v[76:79]
    v_rcp_f32 v111, v111
    s_branch L_past_s2
L_stub_s2:
    s_branch L_back_s
L_past_s2:
    v_mfma_f32_16x16x32_bf16 v[76:79], v[224:227], v[16:19], v[76:79]
    v_rcp_f32 v88, v88
    v_mfma_f32_16x16x32_bf16 v[72:75], v[132:135], v[200:203], v[72:75]
    v_rcp_f32 v89, v89
    v_mfma_f32_16x16x32_bf16 v[72:75], v[212:215], v[92:95], v[72:75]
    v_rcp_f32 v90, v90
    v_mfma_f32_16x16x32_bf16 v[76:79], v[216:219], v[92:95], v[76:79]
    v_rcp_f32 v91, v91
    v_pk_mul_f32 v[108:109], v[108:109], v[40:41]
    v_pk_mul_f32 v[110:111], v[110:111], v[42:43]
    v_pk_mul_f32 v[88:89], v[88:89], v[44:45]
    v_pk_mul_f32 v[90:91], v[90:91], v[46:47]
    v_mfma_f32_16x16x32_bf16 v[76:79], v[112:115], v[200:203], v[76:79]
    v_cvt_pk_bf16_f32 v40, v108, v109
    v_cvt_pk_bf16_f32 v41, v110, v111
    v_mfma_f32_16x16x32_bf16 v[64:67], v[252:255], v[164:167], v[64:67]
    v_cvt_pk_bf16_f32 v42, v88, v89
    v_cvt_pk_bf16_f32 v43, v90, v91
    v_mfma_f32_16x16x32_bf16 v[64:67], v[140:143], v[16:19], v[64:67]
    v_permlane16_swap_b32 v40, v42
    v_mfma_f32_16x16x32_bf16 v[64:67], v[148:151], v[188:191], v[64:67]
    v_permlane16_swap_b32 v41, v43
    v_mfma_f32_16x16x32_bf16 v[68:71], v[156:159], v[188:191], v[68:71]
    buffer_store_dwordx4 v[40:43], v7, s[28:31], s89 offen sc1 nt
    v_exp_f32 v108, v80
    v_mfma_f32_16x16x32_bf16 v[68:71], v[160:163], v[16:19], v[68:71]
    v_exp_f32 v109, v81
    v_mfma_f32_16x16x32_bf16 v[68:71], v[224:227], v[164:167], v[68:71]
    v_exp_f32 v110, v82
    v_mfma_f32_16x16x32_bf16 v[64:67], v[132:135], v[20:23], v[64:67]
    v_exp_f32 v111, v83
    v_mfma_f32_16x16x32_bf16 v[64:67], v[212:215], v[200:203], v[64:67]
    v_exp_f32 v88, v84
    v_mfma_f32_16x16x32_bf16 v[64:67], v[220:223], v[92:95], v[64:67]
    v_exp_f32 v89, v85
    v_mfma_f32_16x16x32_bf16 v[68:71], v[208:211], v[92:95], v[68:71]
    v_exp_f32 v90, v86
    v_mfma_f32_16x16x32_bf16 v[68:71], v[216:219], v[200:203], v[68:71]
    v_exp_f32 v91, v87
    v_pk_fma_f32 v[108:109], v[108:109], s[84:85], s[84:85]
    v_pk_fma_f32 v[110:111], v[110:111], s[84:85], s[84:85]
    v_pk_fma_f32 v[88:89], v[88:89], s[84:85], s[84:85]
    v_pk_fma_f32 v[90:91], v[90:91], s[84:85], s[84:85]
    v_pk_fma_f32 v[48:49], v[48:49], v[176:177], v[184:185]
    v_pk_fma_f32 v[50:51], v[50:51], v[178:179], v[186:187]
    v_pk_fma_f32 v[52:53], v[52:53], v[180:181], v[128:129]
    v_pk_fma_f32 v[54:55], v[54:55], v[182:183], v[130:131]
    v_mfma_f32_16x16x32_bf16 v[68:71], v[112:115], v[20:23], v[68:71]
    v_rcp_f32 v108, v108
    v_rcp_f32 v109, v109
    v_rcp_f32 v110, v110
    v_pk_mul_f32 v[108:109], v[108:109], v[80:81]
    v_rcp_f32 v111, v111
    v_cvt_pk_bf16_f32 v80, v108, v109
    v_rcp_f32 v88, v88
    v_pk_mul_f32 v[110:111], v[110:111], v[82:83]
    v_rcp_f32 v89, v89
    v_cvt_pk_bf16_f32 v81, v110, v111
    v_rcp_f32 v90, v90
    v_pk_mul_f32 v[88:89], v[88:89], v[84:85]
    v_rcp_f32 v91, v91
    v_cvt_pk_bf16_f32 v82, v88, v89
    v_exp_f32 v108, v48
    v_pk_mul_f32 v[90:91], v[90:91], v[86:87]
    v_permlane16_swap_b32 v80, v82
    v_cvt_pk_bf16_f32 v83, v90, v91
    v_exp_f32 v109, v49
    v_exp_f32 v110, v50
    v_pk_fma_f32 v[108:109], v[108:109], s[84:85], s[84:85]
    v_permlane16_swap_b32 v81, v83
    buffer_store_dwordx4 v[80:83], v237, s[28:31], s94 offen
    v_exp_f32 v111, v51
    v_pk_fma_f32 v[56:57], v[56:57], v[176:177], v[184:185]
    v_exp_f32 v88, v52
    v_pk_fma_f32 v[110:111], v[110:111], s[84:85], s[84:85]
    v_exp_f32 v89, v53
    v_pk_fma_f32 v[58:59], v[58:59], v[178:179], v[186:187]
    v_exp_f32 v90, v54
    v_pk_fma_f32 v[88:89], v[88:89], s[84:85], s[84:85]
    v_exp_f32 v91, v55
    v_pk_fma_f32 v[60:61], v[60:61], v[180:181], v[128:129]
    v_rcp_f32 v108, v108
    v_pk_fma_f32 v[90:91], v[90:91], s[84:85], s[84:85]
    v_rcp_f32 v109, v109
    v_pk_fma_f32 v[62:63], v[62:63], v[182:183], v[130:131]
    v_rcp_f32 v110, v110
    v_pk_mul_f32 v[108:109], v[108:109], v[48:49]
    v_rcp_f32 v111, v111
    v_cvt_pk_bf16_f32 v48, v108, v109
    v_rcp_f32 v88, v88
    v_pk_mul_f32 v[110:111], v[110:111], v[50:51]
    v_rcp_f32 v89, v89
    v_cvt_pk_bf16_f32 v49, v110, v111
    v_rcp_f32 v90, v90
    v_pk_mul_f32 v[88:89], v[88:89], v[52:53]
    v_rcp_f32 v91, v91
    v_cvt_pk_bf16_f32 v50, v88, v89
    v_exp_f32 v96, v56
    v_pk_mul_f32 v[90:91], v[90:91], v[54:55]
    v_permlane16_swap_b32 v48, v50
    v_cvt_pk_bf16_f32 v51, v90, v91
    v_exp_f32 v97, v57
    v_exp_f32 v98, v58
    v_pk_fma_f32 v[96:97], v[96:97], s[84:85], s[84:85]
    v_permlane16_swap_b32 v49, v51
    buffer_store_dwordx4 v[48:51], v7, s[28:31], s90 offen sc1 nt
    v_exp_f32 v99, v59
    v_pk_fma_f32 v[72:73], v[72:73], v[176:177], v[184:185]
    v_exp_f32 v232, v60
    v_pk_fma_f32 v[98:99], v[98:99], s[84:85], s[84:85]
    v_exp_f32 v233, v61
    v_pk_fma_f32 v[74:75], v[74:75], v[178:179], v[186:187]
    v_exp_f32 v234, v62
    v_pk_fma_f32 v[232:233], v[232:233], s[84:85], s[84:85]
    v_exp_f32 v235, v63
    v_pk_fma_f32 v[76:77], v[76:77], v[180:181], v[128:129]
    v_rcp_f32 v96, v96
    v_pk_fma_f32 v[234:235], v[234:235], s[84:85], s[84:85]
    v_rcp_f32 v97, v97
    v_pk_fma_f32 v[78:79], v[78:79], v[182:183], v[130:131]
    v_rcp_f32 v98, v98
    v_pk_mul_f32 v[96:97], v[96:97], v[56:57]
    v_rcp_f32 v99, v99
    v_cvt_pk_bf16_f32 v56, v96, v97
    v_rcp_f32 v232, v232
    v_pk_mul_f32 v[98:99], v[98:99], v[58:59]
    v_rcp_f32 v233, v233
    v_cvt_pk_bf16_f32 v57, v98, v99
    v_rcp_f32 v234, v234
    s_branch L_past_s3
L_stub_s3:
    s_branch L_back_s
L_past_s3:
    v_pk_mul_f32 v[232:233], v[232:233], v[60:61]
    v_rcp_f32 v235, v235
    v_cvt_pk_bf16_f32 v58, v232, v233
    v_exp_f32 v104, v72
    v_pk_mul_f32 v[234:235], v[234:235], v[62:63]
    v_permlane16_swap_b32 v56, v58
    v_cvt_pk_bf16_f32 v59, v234, v235
    v_exp_f32 v105, v73
    v_exp_f32 v106, v74
    v_pk_fma_f32 v[104:105], v[104:105], s[84:85], s[84:85]
    v_permlane16_swap_b32 v57, v59
    buffer_store_dwordx4 v[56:59], v7, s[28:31], s91 offen sc1 nt
    v_exp_f32 v107, v75
    v_pk_fma_f32 v[64:65], v[64:65], v[176:177], v[184:185]
    v_exp_f32 v100, v76
    v_pk_fma_f32 v[106:107], v[106:107], s[84:85], s[84:85]
    v_exp_f32 v101, v77
    v_pk_fma_f32 v[66:67], v[66:67], v[178:179], v[186:187]
    v_exp_f32 v102, v78
    v_pk_fma_f32 v[100:101], v[100:101], s[84:85], s[84:85]
    v_exp_f32 v103, v79
    v_pk_fma_f32 v[68:69], v[68:69], v[180:181], v[128:129]
    v_rcp_f32 v104, v104
    v_pk_fma_f32 v[102:103], v[102:103], s[84:85], s[84:85]
    v_rcp_f32 v105, v105
    v_pk_fma_f32 v[70:71], v[70:71], v[182:183], v[130:131]
    v_rcp_f32 v106, v106
    v_pk_mul_f32 v[104:105], v[104:105], v[72:73]
    v_rcp_f32 v107, v107
    v_cvt_pk_bf16_f32 v72, v104, v105
    v_rcp_f32 v100, v100
    v_pk_mul_f32 v[106:107], v[106:107], v[74:75]
    v_rcp_f32 v101, v101
    v_cvt_pk_bf16_f32 v73, v106, v107
    v_rcp_f32 v102, v102
    v_pk_mul_f32 v[100:101], v[100:101], v[76:77]
    v_rcp_f32 v103, v103
    v_cvt_pk_bf16_f32 v74, v100, v101
    v_exp_f32 v108, v64
    v_pk_mul_f32 v[102:103], v[102:103], v[78:79]
    v_permlane16_swap_b32 v72, v74
    v_cvt_pk_bf16_f32 v75, v102, v103
    v_exp_f32 v109, v65
    v_exp_f32 v110, v66
    v_pk_fma_f32 v[108:109], v[108:109], s[84:85], s[84:85]
    v_permlane16_swap_b32 v73, v75
    buffer_store_dwordx4 v[72:75], v7, s[28:31], s93 offen sc1 nt
    v_exp_f32 v111, v67
    v_exp_f32 v88, v68
    v_pk_fma_f32 v[110:111], v[110:111], s[84:85], s[84:85]
    v_exp_f32 v89, v69
    v_exp_f32 v90, v70
    v_pk_fma_f32 v[88:89], v[88:89], s[84:85], s[84:85]
    v_exp_f32 v91, v71
    v_rcp_f32 v108, v108
    v_pk_fma_f32 v[90:91], v[90:91], s[84:85], s[84:85]
    v_rcp_f32 v109, v109
    v_rcp_f32 v110, v110
    v_pk_mul_f32 v[108:109], v[108:109], v[64:65]
    v_rcp_f32 v111, v111
    v_cvt_pk_bf16_f32 v64, v108, v109
    v_rcp_f32 v88, v88
    v_pk_mul_f32 v[110:111], v[110:111], v[66:67]
    v_rcp_f32 v89, v89
    v_cvt_pk_bf16_f32 v65, v110, v111
    v_rcp_f32 v90, v90
    v_pk_mul_f32 v[88:89], v[88:89], v[68:69]
    v_rcp_f32 v91, v91
    v_cvt_pk_bf16_f32 v66, v88, v89
    v_pk_mul_f32 v[90:91], v[90:91], v[70:71]
    s_nop 0
    v_permlane16_swap_b32 v64, v66
    v_cvt_pk_bf16_f32 v67, v90, v91
    s_nop 0
    s_nop 0
    v_permlane16_swap_b32 v65, v67
    buffer_store_dwordx4 v[64:67], v7, s[28:31], s92 offen sc1 nt
L_tend_s:
    s_endpgm
L_fin_s:
L_end:
    s_endpgm
.section .rodata,"a"
.p2align 6
.amdhsa_kernel standalone__batchnorm__sampling_kernel
  .amdhsa_next_free_vgpr 256
  .amdhsa_next_free_sgpr 102
  .amdhsa_accum_offset 256
  .amdhsa_group_segment_fixed_size 0
  .amdhsa_kernarg_size 72
  .amdhsa_user_sgpr_count 2
  .amdhsa_user_sgpr_kernarg_segment_ptr 1
  .amdhsa_system_sgpr_workgroup_id_x 1
  .amdhsa_float_denorm_mode_32 3
.end_amdhsa_kernel
```
